```python
import torch

def _softmax(x, axis=-1):
    return torch.softmax(x, dim=axis)
def _gelu(x):
    return torch.nn.functional.gelu(x, approximate="tanh")
def _silu(x):
    return torch.nn.functional.silu(x)
def _sigmoid(x):
    return torch.sigmoid(x)
def _layernorm(x, axis=-1, eps=1e-5):
    m = x.mean(dim=axis, keepdim=True)
    v = x.var(dim=axis, keepdim=True, unbiased=False)
    return (x - m) / torch.sqrt(v + eps)
def _scatter_add(tgt, idx, src, axis=0):
    return tgt.clone().index_add_(axis, idx, src)
def _segment_sum(src, seg, n):
    out = torch.zeros((n,) + src.shape[1:], dtype=src.dtype)
    return out.index_add_(0, seg, src)
def _pad(x, pw):
    flat = tuple(v for pair in reversed(pw) for v in pair)
    return torch.nn.functional.pad(x, flat)

kernel_name = 'gated_mix__mha_block_cached__glu_gated_glu__decode'

def setup_inputs():

    _w = (lambda a: (lambda t: t.to(torch.bfloat16) if t.is_floating_point() else t)(torch.as_tensor(a)))
    def _A_setup():
        B, Sq, D = 2, 1, 448
        H, Sk, Dh = 16, 8192, 256
        return {
            "x": _w((lambda *s: torch.randn(*s, dtype=torch.bfloat16) * 0.05)(B, Sq, D)),
            "k_cache": _w((lambda *s: torch.randn(*s, dtype=torch.bfloat16) * 6.4)(B, H, Sk, Dh)),
            "v_cache": _w((lambda *s: torch.randn(*s, dtype=torch.bfloat16) * 0.4)(B, H, Sk, Dh)),
            "wq": _w((lambda *s: torch.randn(*s, dtype=torch.bfloat16) * 6.4)(D, H * Dh) * (D ** -0.5)),
            "wo": _w((lambda *s: torch.randn(*s, dtype=torch.bfloat16) * 0.4)(H * Dh, D) * ((H * Dh) ** -0.5)),
        }
    _A_in = _A_setup()

    def _B_setup():
        B, S, D, F = 2, 1, 448, 1792
        return {
            "x": _w((lambda *s: torch.randn(*s, dtype=torch.bfloat16) * 0.05)(B, S, D)),
            "w_gate": _w((lambda *s: torch.randn(*s, dtype=torch.bfloat16) * 0.4)(D, F)),
            "w_up": _w((lambda *s: torch.randn(*s, dtype=torch.bfloat16) * 0.05)(D, F)),
            "w_down": _w((lambda *s: torch.randn(*s, dtype=torch.bfloat16) * 0.05)(F, D)),
        }
    _B_in = _B_setup()

    return {
        "A_x": _A_in["x"],
        "A_k_cache": _A_in["k_cache"],
        "A_v_cache": _A_in["v_cache"],
        "A_wq": _A_in["wq"],
        "A_wo": _A_in["wo"],
        "B_x": _B_in["x"],
        "B_w_gate": _B_in["w_gate"],
        "B_w_up": _B_in["w_up"],
        "B_w_down": _B_in["w_down"],
        "gate_w": _w((lambda *s: torch.randn(*s, dtype=torch.bfloat16) * 0.05)(448) * 16.0),
    }

def reference(A_x, A_k_cache, A_v_cache, A_wq, A_wo, B_x, B_w_gate, B_w_up, B_w_down, gate_w):
    def _A_ref(x, k_cache, v_cache, wq, wo):
        B, Sq, D = x.shape
        H, Dh = 16, 256
        q = (lambda x, *d: x.permute(*d))((x @ wq).reshape(B, Sq, H, Dh), 0, 2, 1, 3)
        scores = torch.einsum("bhqd,bhkd->bhqk", q, k_cache) * (Dh ** -0.5)
        p = _softmax(scores, axis=-1)
        o = torch.einsum("bhqk,bhkd->bhqd", p, v_cache)
        return (lambda x, *d: x.permute(*d))(o, 0, 2, 1, 3).reshape(B, Sq, H * Dh) @ wo

    def _B_ref(x, w_gate, w_up, w_down):
        g = torch.einsum("bsd,df->bsf", x, w_gate)
        u = torch.einsum("bsd,df->bsf", x, w_up)
        h = _sigmoid(g) * u
        return torch.einsum("bsf,fd->bsd", h, w_down)

    x = A_x
    g = _sigmoid((x * gate_w).sum(-1, keepdims=True))
    a = _A_ref(x, A_k_cache, A_v_cache, A_wq, A_wo)
    b = _B_ref(x, B_w_gate, B_w_up, B_w_down)
    return g * a + (1 - g) * b
```

```asm
; @launch grid=(256,1,1) block=(512,1,1) lds=81920
.amdgcn_target "amdgcn-amd-amdhsa--gfx950"
.text
.globl gated_mix__mha_block_cached__glu_gated_glu__decode_kernel
.p2align 8
.type gated_mix__mha_block_cached__glu_gated_glu__decode_kernel,@function
gated_mix__mha_block_cached__glu_gated_glu__decode_kernel:
  s_cmp_ge_u32 s2, 256
  s_cbranch_scc1 L_end
  s_load_dwordx16 s[4:19], s[0:1], 0
  s_load_dwordx8 s[20:27], s[0:1], 64
  s_load_dwordx2 s[28:29], s[0:1], 96
  v_lshrrev_b32 v1, 6, v0
  v_and_b32 v0, 63, v0
  s_lshr_b32 s30, s2, 7
  v_readfirstlane_b32 s3, v1
  s_and_b32 s32, s2, 7
  s_bfe_u32 s33, s2, 0x40003
  s_and_b32 s31, s33, 1
  s_lshl_b32 s34, s30, 4
  s_add_u32 s34, s34, s33
  s_cmp_ge_u32 s3, 4
  s_cbranch_scc1 L_stream
  s_setprio 3
  s_lshl_b32 s57, s30, 3
  s_add_u32 s57, s57, s32
  s_mov_b32 s56, 200000
  s_and_b32 s50, s57, 3
  s_lshr_b32 s51, s57, 2
  s_cmp_lt_u32 s51, 2
  s_cselect_b32 s52, 4, 3
  s_lshl_b32 s53, s51, 7
  s_mul_i32 s58, s51, 96
  s_add_u32 s58, s58, 64
  s_cselect_b32 s53, s53, s53
  s_cmp_lt_u32 s51, 2
  s_cselect_b32 s53, s53, s58
  v_lshrrev_b32 v1, 3, v0
  v_lshlrev_b32 v2, 13, v1
  v_and_b32 v1, 7, v0
  v_lshlrev_b32 v1, 4, v1
  s_lshl_b32 s58, s33, 9
  s_lshl_b32 s59, s50, 7
  s_add_u32 s58, s58, s59
  v_add3_u32 v2, v2, v1, s58
  s_lshl_b32 s57, s3, 5
  s_add_u32 s57, s57, s53
  s_lshl_b32 s57, s57, 13
  s_lshl_b32 s59, s3, 12
  s_add_u32 s59, s59, 8192
  s_waitcnt lgkmcnt(0)
  s_load_dwordx2 s[46:47], s[28:29], 0
  s_mov_b32 s40, s10
  s_mov_b32 s41, s11
  s_mov_b32 s42, 3670016
  s_mov_b32 s43, 0x20000
  s_cmp_lt_u32 s3, s52
  s_cbranch_scc0 L_no_qtile
  s_add_u32 m0, s59, 0
  s_nop 0
  buffer_load_dwordx4 v2, s[40:43], s57 offen nt lds
  s_add_u32 m0, s59, 1024
  s_add_u32 s57, s57, 65536
  buffer_load_dwordx4 v2, s[40:43], s57 offen nt lds
  s_add_u32 m0, s59, 2048
  s_add_u32 s57, s57, 65536
  buffer_load_dwordx4 v2, s[40:43], s57 offen nt lds
  s_add_u32 m0, s59, 3072
  s_add_u32 s57, s57, 65536
  buffer_load_dwordx4 v2, s[40:43], s57 offen nt lds
L_no_qtile:
  s_cmp_eq_u32 s3, 0
  s_cbranch_scc0 L_h_b0
  s_mov_b32 s96, s4
  s_mov_b32 s97, s5
  s_mov_b32 s98, 1792
  s_mov_b32 s99, 0x20000
  v_lshlrev_b32 v1, 4, v0
  s_mov_b32 m0, 0
  v_mov_b32 v20, 0
  v_mov_b32 v25, 0
  v_mov_b32 v22, 0
  v_mov_b32 v23, 0
  v_mov_b32 v24, 0
  buffer_load_dwordx4 v1, s[96:99], 0 offen lds
  buffer_load_dwordx4 v1, s[96:99], 0 offen offset:1024 lds
  ds_write_b128 v20, v[22:25] offset:2688
  ds_write_b128 v20, v[22:25] offset:2704
  s_waitcnt lgkmcnt(0)
L_h_b0:
  s_barrier
  s_mov_b32 s36, s28
  s_mov_b32 s37, s29
  s_mov_b32 s38, 1703936
  s_mov_b32 s39, 0x20000
  s_mov_b32 s48, 0
  s_mov_b32 s61, 0
  s_mov_b32 s40, s20
  s_mov_b32 s41, s21
  s_mov_b32 s42, 1605632
  s_mov_b32 s49, 896
  s_mov_b32 s44, 0
  s_mov_b32 s45, 0
  s_mov_b32 s62, 0
  s_mov_b32 s63, 0
  s_cmp_lt_u32 s32, 4
  s_cbranch_scc0 L_role_done
  s_lshl_b32 s57, s34, 2
  s_add_u32 s57, s57, s32
  s_cmp_lt_u32 s57, 84
  s_cbranch_scc0 L_role_done
L_role_u:
  s_cmp_lt_u32 s57, 56
  s_cbranch_scc0 L_role_f2
  s_mov_b32 s48, 1
  s_mov_b32 s49, 3584
  s_and_b32 s58, s57, 1
  s_lshr_b32 s59, s57, 1
  s_lshl_b32 s44, s59, 7
  s_cmp_eq_u32 s58, 0
  s_cselect_b32 s40, s16, s18
  s_cselect_b32 s41, s17, s19
  s_mov_b32 s42, 1605632
  s_lshl_b32 s62, s58, 14
  s_lshl_b32 s59, s59, 8
  s_add_u32 s62, s62, s59
  s_add_u32 s62, s62, 131072
  s_branch L_role_done
L_role_f2:
  s_mov_b32 s48, 2
  s_sub_u32 s57, s57, 56
  s_mul_i32 s58, s57, 37
  s_lshr_b32 s58, s58, 8
  s_mul_i32 s59, s58, 7
  s_sub_u32 s59, s57, s59
  s_lshl_b32 s44, s59, 7
  s_mul_i32 s45, s58, 448
  s_lshl_b32 s62, s59, 2
  s_add_u32 s62, s62, s58
  s_lshl_b32 s62, s62, 9
  s_add_u32 s62, s62, 262144
  s_mov_b32 s63, s58
L_role_done:
  s_mov_b32 s35, s34
  s_mov_b32 s100, s3
  s_cmp_eq_u32 s32, 5
  s_cselect_b32 s61, 1, 0
  s_cmp_lt_u32 s35, 14
  s_cselect_b32 s61, s61, 0
  v_lshrrev_b32 v7, 4, v0
  v_lshlrev_b32 v6, 3, v7
  v_bfe_u32 v1, v0, 2, 2
  v_add_u32 v6, v6, v1
  v_lshlrev_b32 v6, 7, v6
  v_and_b32 v1, 3, v0
  v_lshlrev_b32 v1, 3, v1
  v_add_u32 v6, v6, v1
  s_lshl_b32 s57, s3, 5
  v_add_u32 v6, s57, v6
  v_lshlrev_b32 v7, 4, v7
  v_bfe_u32 v16, v0, 2, 1
  v_mul_u32_u24 v5, 896, v16
  v_add_u32 v5, v5, v7
  v_add_u32 v17, 24576, v6
  s_waitcnt lgkmcnt(0)
  s_add_u32 s54, s46, 1
  s_add_u32 s55, s47, 1
  v_mov_b32 v10, s54
  v_mov_b32 v11, s55
  s_waitcnt vmcnt(0) lgkmcnt(0)
  v_mov_b32 v60, 0
  v_mov_b32 v61, 1
  s_mov_b64 exec, 1
  ds_add_u32 v60, v61 offset:2688
  s_mov_b64 exec, -1
L_hs1:
  ds_read_b32 v61, v60 offset:2688
  s_sub_i32 s56, s56, 1
  s_cmp_lt_i32 s56, 1
  s_cbranch_scc1 L_hsd2
  s_waitcnt lgkmcnt(0)
  v_cmp_gt_u32 vcc, 4, v61
  s_cbranch_vccnz L_hs1
L_hsd2:
  s_waitcnt lgkmcnt(0)
  s_lshl_b32 s57, s53, 1
  v_add_u32 v18, s57, v5
  v_add_u32 v19, 8192, v6
  ds_read_b128 v[64:67], v18 offset:0
  ds_read_b64_tr_b16 v[184:185], v19 offset:0
  ds_read_b64_tr_b16 v[186:187], v19 offset:512
  ds_read_b128 v[68:71], v18 offset:64
  ds_read_b64_tr_b16 v[188:189], v19 offset:4096
  ds_read_b64_tr_b16 v[190:191], v19 offset:4608
  ds_read_b128 v[72:75], v18 offset:128
  ds_read_b64_tr_b16 v[192:193], v19 offset:8192
  ds_read_b64_tr_b16 v[194:195], v19 offset:8704
  s_cmp_lt_u32 s52, 4
  s_cbranch_scc1 L_q3
  ds_read_b128 v[76:79], v18 offset:192
  ds_read_b64_tr_b16 v[196:197], v19 offset:12288
  ds_read_b64_tr_b16 v[198:199], v19 offset:12800
  s_waitcnt lgkmcnt(0)
  v_mfma_f32_16x16x32_bf16 v[12:15], v[76:79], v[196:199], 0
  s_branch L_q4
L_q3:
  v_mov_b32 v12, 0
  v_mov_b32 v13, 0
  v_mov_b32 v14, 0
  v_mov_b32 v15, 0
  s_waitcnt lgkmcnt(0)
L_q4:
  s_nop 0
  v_mfma_f32_16x16x32_bf16 v[12:15], v[64:67], v[184:187], v[12:15]
  v_mfma_f32_16x16x32_bf16 v[12:15], v[68:71], v[188:191], v[12:15]
  v_mfma_f32_16x16x32_bf16 v[12:15], v[72:75], v[192:195], v[12:15]
  v_lshrrev_b32 v18, 4, v0
  v_lshlrev_b32 v18, 13, v18
  v_bfe_u32 v19, v0, 1, 3
  v_lshlrev_b32 v19, 4, v19
  v_add_u32 v18, v18, v19
  s_lshl_b32 s58, s33, 14
  s_lshl_b32 s59, s51, 11
  s_add_u32 s58, s58, s59
  s_lshl_b32 s59, s50, 9
  s_add_u32 s58, s58, s59
  s_lshl_b32 s59, s3, 7
  s_add_u32 s58, s58, s59
  s_add_u32 s58, s58, 1114112
  v_mov_b32 v8, v12
  v_mov_b32_dpp v9, v12 row_shl:1 row_mask:0xf bank_mask:0xf
  s_mov_b32 exec_lo, 0x55555555
  s_mov_b32 exec_hi, 0
  buffer_store_dwordx4 v[8:11], v18, s[36:39], s58 offen sc1
  s_mov_b64 exec, -1
  v_lshrrev_b32 v18, 5, v0
  v_lshlrev_b32 v18, 12, v18
  v_and_b32 v19, 31, v0
  v_lshlrev_b32 v20, 4, v19
  v_add_u32 v18, v18, v20
  v_lshlrev_b32 v19, 2, v19
  s_lshl_b32 s57, s3, 7
  v_add_u32 v19, s57, v19
  s_lshl_b32 s58, s33, 14
  s_lshl_b32 s59, s30, 13
  s_add_u32 s58, s58, s59
  s_lshl_b32 s59, s3, 9
  s_add_u32 s58, s58, s59
  s_add_u32 s58, s58, 1114112
  s_add_u32 s59, s58, 2048
L_poll3:
  s_sleep 20
  buffer_load_dwordx4 v[20:23], v18, s[36:39], s58 offen sc1
  buffer_load_dwordx4 v[24:27], v18, s[36:39], s59 offen sc1
  s_sub_i32 s56, s56, 1
  s_cmp_lt_i32 s56, 1
  s_cbranch_scc1 L_polld4
  s_waitcnt vmcnt(0)
  v_xor_b32 v60, s54, v22
  v_xor_b32 v61, s55, v23
  v_or_b32 v60, v60, v61
  v_xor_b32 v62, s54, v26
  v_xor_b32 v61, s55, v27
  v_or3_b32 v60, v60, v61, v62
  v_cmp_ne_u32 vcc, 0, v60
  s_cbranch_vccnz L_poll3
L_polld4:
  s_waitcnt vmcnt(0)
  v_add_f32 v20, v20, v24
  v_add_f32 v21, v21, v25
  v_mov_b32 v24, v20
  v_mov_b32 v25, v21
  s_nop 0
  v_permlane32_swap_b32 v20, v24
  v_permlane32_swap_b32 v21, v25
  v_add_f32 v20, v20, v24
  v_add_f32 v21, v21, v25
  v_cvt_pk_bf16_f32 v20, v20, v21
  ds_write_b32 v19, v20 offset:2048
  s_waitcnt lgkmcnt(0)
L_h_b1:
  s_barrier
  s_mov_b32 s56, 200000
  s_cmp_eq_u32 s48, 1
  s_cbranch_scc0 L_h_nof1
  v_lshrrev_b32 v1, 3, v0
  v_mul_lo_u32 v2, v1, s49
  v_and_b32 v1, 7, v0
  v_lshlrev_b32 v1, 4, v1
  v_add3_u32 v2, v2, v1, s44
  s_mul_i32 s57, s3, 112
  s_add_u32 s57, s57, s45
  s_mul_i32 s57, s57, s49
  s_lshl_b32 s58, s49, 3
  s_mul_i32 s59, s3, 14336
  s_add_u32 s59, s59, 24576
  s_add_u32 m0, s59, 0
  s_nop 0
  buffer_load_dwordx4 v2, s[40:43], s57 offen nt lds
  s_add_u32 m0, s59, 1024
  s_add_u32 s57, s57, s58
  buffer_load_dwordx4 v2, s[40:43], s57 offen nt lds
  s_add_u32 m0, s59, 2048
  s_add_u32 s57, s57, s58
  buffer_load_dwordx4 v2, s[40:43], s57 offen nt lds
  s_add_u32 m0, s59, 3072
  s_add_u32 s57, s57, s58
  buffer_load_dwordx4 v2, s[40:43], s57 offen nt lds
  s_add_u32 m0, s59, 4096
  s_add_u32 s57, s57, s58
  buffer_load_dwordx4 v2, s[40:43], s57 offen nt lds
  s_add_u32 m0, s59, 5120
  s_add_u32 s57, s57, s58
  buffer_load_dwordx4 v2, s[40:43], s57 offen nt lds
  s_add_u32 m0, s59, 6144
  s_add_u32 s57, s57, s58
  buffer_load_dwordx4 v2, s[40:43], s57 offen nt lds
  s_add_u32 m0, s59, 7168
  s_add_u32 s57, s57, s58
  buffer_load_dwordx4 v2, s[40:43], s57 offen nt lds
  s_add_u32 m0, s59, 8192
  s_add_u32 s57, s57, s58
  buffer_load_dwordx4 v2, s[40:43], s57 offen nt lds
  s_add_u32 m0, s59, 9216
  s_add_u32 s57, s57, s58
  buffer_load_dwordx4 v2, s[40:43], s57 offen nt lds
  s_add_u32 m0, s59, 10240
  s_add_u32 s57, s57, s58
  buffer_load_dwordx4 v2, s[40:43], s57 offen nt lds
  s_add_u32 m0, s59, 11264
  s_add_u32 s57, s57, s58
  buffer_load_dwordx4 v2, s[40:43], s57 offen nt lds
  s_add_u32 m0, s59, 12288
  s_add_u32 s57, s57, s58
  buffer_load_dwordx4 v2, s[40:43], s57 offen nt lds
  s_add_u32 m0, s59, 13312
  s_add_u32 s57, s57, s58
  buffer_load_dwordx4 v2, s[40:43], s57 offen nt lds
  s_waitcnt vmcnt(0) lgkmcnt(0)
  v_mov_b32 v60, 0
  v_mov_b32 v61, 1
  s_mov_b64 exec, 1
  ds_add_u32 v60, v61 offset:2692
  s_mov_b64 exec, -1
L_hs5:
  ds_read_b32 v61, v60 offset:2692
  s_sub_i32 s56, s56, 1
  s_cmp_lt_i32 s56, 1
  s_cbranch_scc1 L_hsd6
  s_waitcnt lgkmcnt(0)
  v_cmp_gt_u32 vcc, 4, v61
  s_cbranch_vccnz L_hs5
L_hsd6:
  s_waitcnt lgkmcnt(0)
  ds_read_b128 v[64:67], v5 offset:0
  ds_read_b64_tr_b16 v[184:185], v17 offset:0
  ds_read_b64_tr_b16 v[186:187], v17 offset:512
  ds_read_b128 v[68:71], v5 offset:64
  ds_read_b64_tr_b16 v[188:189], v17 offset:4096
  ds_read_b64_tr_b16 v[190:191], v17 offset:4608
  ds_read_b128 v[72:75], v5 offset:128
  ds_read_b64_tr_b16 v[192:193], v17 offset:8192
  ds_read_b64_tr_b16 v[194:195], v17 offset:8704
  ds_read_b128 v[76:79], v5 offset:192
  ds_read_b64_tr_b16 v[196:197], v17 offset:12288
  ds_read_b64_tr_b16 v[198:199], v17 offset:12800
  ds_read_b128 v[80:83], v5 offset:256
  ds_read_b64_tr_b16 v[200:201], v17 offset:16384
  ds_read_b64_tr_b16 v[202:203], v17 offset:16896
  s_waitcnt lgkmcnt(12)
  v_mfma_f32_16x16x32_bf16 v[12:15], v[64:67], v[184:187], 0
  ds_read_b128 v[84:87], v5 offset:320
  ds_read_b64_tr_b16 v[204:205], v17 offset:20480
  ds_read_b64_tr_b16 v[206:207], v17 offset:20992
  s_waitcnt lgkmcnt(12)
  v_mfma_f32_16x16x32_bf16 v[12:15], v[68:71], v[188:191], v[12:15]
  ds_read_b128 v[88:91], v5 offset:384
  ds_read_b64_tr_b16 v[208:209], v17 offset:24576
  ds_read_b64_tr_b16 v[210:211], v17 offset:25088
  s_waitcnt lgkmcnt(12)
  v_mfma_f32_16x16x32_bf16 v[12:15], v[72:75], v[192:195], v[12:15]
  ds_read_b128 v[92:95], v5 offset:448
  ds_read_b64_tr_b16 v[212:213], v17 offset:28672
  ds_read_b64_tr_b16 v[214:215], v17 offset:29184
  s_waitcnt lgkmcnt(12)
  v_mfma_f32_16x16x32_bf16 v[12:15], v[76:79], v[196:199], v[12:15]
  ds_read_b128 v[96:99], v5 offset:512
  ds_read_b64_tr_b16 v[216:217], v17 offset:32768
  ds_read_b64_tr_b16 v[218:219], v17 offset:33280
  s_waitcnt lgkmcnt(12)
  v_mfma_f32_16x16x32_bf16 v[12:15], v[80:83], v[200:203], v[12:15]
  ds_read_b128 v[100:103], v5 offset:576
  ds_read_b64_tr_b16 v[220:221], v17 offset:36864
  ds_read_b64_tr_b16 v[222:223], v17 offset:37376
  s_waitcnt lgkmcnt(12)
  v_mfma_f32_16x16x32_bf16 v[12:15], v[84:87], v[204:207], v[12:15]
  ds_read_b128 v[104:107], v5 offset:640
  ds_read_b64_tr_b16 v[224:225], v17 offset:40960
  ds_read_b64_tr_b16 v[226:227], v17 offset:41472
  s_waitcnt lgkmcnt(12)
  v_mfma_f32_16x16x32_bf16 v[12:15], v[88:91], v[208:211], v[12:15]
  ds_read_b128 v[108:111], v5 offset:704
  ds_read_b64_tr_b16 v[228:229], v17 offset:45056
  ds_read_b64_tr_b16 v[230:231], v17 offset:45568
  s_waitcnt lgkmcnt(12)
  v_mfma_f32_16x16x32_bf16 v[12:15], v[92:95], v[212:215], v[12:15]
  ds_read_b128 v[112:115], v5 offset:768
  ds_read_b64_tr_b16 v[232:233], v17 offset:49152
  ds_read_b64_tr_b16 v[234:235], v17 offset:49664
  s_waitcnt lgkmcnt(12)
  v_mfma_f32_16x16x32_bf16 v[12:15], v[96:99], v[216:219], v[12:15]
  ds_read_b128 v[116:119], v5 offset:832
  ds_read_b64_tr_b16 v[236:237], v17 offset:53248
  ds_read_b64_tr_b16 v[238:239], v17 offset:53760
  s_waitcnt lgkmcnt(12)
  v_mfma_f32_16x16x32_bf16 v[12:15], v[100:103], v[220:223], v[12:15]
  s_waitcnt lgkmcnt(9)
  v_mfma_f32_16x16x32_bf16 v[12:15], v[104:107], v[224:227], v[12:15]
  s_waitcnt lgkmcnt(6)
  v_mfma_f32_16x16x32_bf16 v[12:15], v[108:111], v[228:231], v[12:15]
  s_waitcnt lgkmcnt(3)
  v_mfma_f32_16x16x32_bf16 v[12:15], v[112:115], v[232:235], v[12:15]
  s_waitcnt lgkmcnt(0)
  v_mfma_f32_16x16x32_bf16 v[12:15], v[116:119], v[236:239], v[12:15]
  s_nop 7
  v_mov_b32_dpp v18, v12 row_shl:1 row_mask:0xf bank_mask:0xf
  v_cvt_pk_bf16_f32 v8, v12, v18
  v_lshrrev_b32 v18, 4, v0
  v_lshlrev_b32 v18, 13, v18
  v_mov_b32_dpp v9, v8 row_shl:2 row_mask:0xf bank_mask:0xf
  v_bfe_u32 v19, v0, 2, 2
  v_lshlrev_b32 v19, 4, v19
  v_add_u32 v18, v18, v19
  s_lshl_b32 s58, s3, 6
  s_add_u32 s58, s58, s62
  s_mov_b32 exec_lo, 0x11111111
  s_mov_b32 exec_hi, 0
  buffer_store_dwordx4 v[8:11], v18, s[36:39], s58 offen sc1
  s_mov_b64 exec, -1
L_h_nof1:
  s_cmp_eq_u32 s61, 1
  s_cbranch_scc0 L_h_b2
  s_mov_b32 s40, s22
  s_mov_b32 s41, s23
  s_mov_b32 s42, 896
  s_mov_b32 s43, 0x20000
  s_cmp_ge_u32 s35, 7
  s_cselect_b32 s49, 1, 0
  s_mul_i32 s50, s49, 7
  s_sub_u32 s50, s35, s50
  v_lshlrev_b32 v18, 4, v0
  buffer_load_dwordx4 v[20:23], v18, s[40:43], 0 offen
  s_mul_i32 s57, s49, 896
  v_add_u32 v18, s57, v18
  ds_read_b128 v[26:29], v18 offset:0
  s_waitcnt vmcnt(0) lgkmcnt(0)
  v_mov_b32 v30, 0
  v_lshlrev_b32 v31, 16, v20
  v_and_b32 v32, 0xffff0000, v20
  v_lshlrev_b32 v33, 16, v26
  v_and_b32 v34, 0xffff0000, v26
  v_mul_f32 v31, v31, v33
  v_mul_f32 v32, v32, v34
  v_cvt_pk_bf16_f32 v31, v31, v32
  v_lshlrev_b32 v32, 16, v31
  v_and_b32 v31, 0xffff0000, v31
  v_add_f32 v30, v30, v32
  v_add_f32 v30, v30, v31
  v_lshlrev_b32 v31, 16, v21
  v_and_b32 v32, 0xffff0000, v21
  v_lshlrev_b32 v33, 16, v27
  v_and_b32 v34, 0xffff0000, v27
  v_mul_f32 v31, v31, v33
  v_mul_f32 v32, v32, v34
  v_cvt_pk_bf16_f32 v31, v31, v32
  v_lshlrev_b32 v32, 16, v31
  v_and_b32 v31, 0xffff0000, v31
  v_add_f32 v30, v30, v32
  v_add_f32 v30, v30, v31
  v_lshlrev_b32 v31, 16, v22
  v_and_b32 v32, 0xffff0000, v22
  v_lshlrev_b32 v33, 16, v28
  v_and_b32 v34, 0xffff0000, v28
  v_mul_f32 v31, v31, v33
  v_mul_f32 v32, v32, v34
  v_cvt_pk_bf16_f32 v31, v31, v32
  v_lshlrev_b32 v32, 16, v31
  v_and_b32 v31, 0xffff0000, v31
  v_add_f32 v30, v30, v32
  v_add_f32 v30, v30, v31
  v_lshlrev_b32 v31, 16, v23
  v_and_b32 v32, 0xffff0000, v23
  v_lshlrev_b32 v33, 16, v29
  v_and_b32 v34, 0xffff0000, v29
  v_mul_f32 v31, v31, v33
  v_mul_f32 v32, v32, v34
  v_cvt_pk_bf16_f32 v31, v31, v32
  v_lshlrev_b32 v32, 16, v31
  v_and_b32 v31, 0xffff0000, v31
  v_add_f32 v30, v30, v32
  v_add_f32 v30, v30, v31
  s_nop 1
  v_add_f32_dpp v30, v30, v30 row_ror:8 row_mask:0xf bank_mask:0xf
  s_nop 1
  v_add_f32_dpp v30, v30, v30 row_ror:4 row_mask:0xf bank_mask:0xf
  s_nop 1
  v_add_f32_dpp v30, v30, v30 row_ror:2 row_mask:0xf bank_mask:0xf
  s_nop 1
  v_add_f32_dpp v30, v30, v30 row_ror:1 row_mask:0xf bank_mask:0xf
  v_mov_b32 v31, v30
  s_nop 1
  v_permlane16_swap_b32 v30, v31
  v_add_f32 v30, v30, v31
  v_mov_b32 v31, v30
  s_nop 1
  v_permlane32_swap_b32 v30, v31
  v_add_f32 v30, v30, v31
  v_cvt_pk_bf16_f32 v30, v30, v30
  s_mov_b32 s57, 3216550459
  v_lshlrev_b32 v30, 16, v30
  v_mul_f32 v30, s57, v30
  v_exp_f32 v30, v30
  s_nop 0
  v_add_f32 v30, 1.0, v30
  v_rcp_f32 v30, v30
  s_nop 0
  v_cvt_pk_bf16_f32 v30, v30, v30
  v_lshlrev_b32 v178, 16, v30
  v_sub_f32 v179, 1.0, v178
  v_cvt_pk_bf16_f32 v179, v179, v179
  v_lshlrev_b32 v179, 16, v179
L_h_b2:
L_h_notr:
  s_mov_b32 s56, 200000
  v_mov_b32 v60, 0
L_h_mlw:
  ds_read_b32 v61, v60 offset:2704
  s_sub_i32 s56, s56, 1
  s_cmp_lt_i32 s56, 1
  s_cbranch_scc1 L_h_mlwd
  s_waitcnt lgkmcnt(0)
  v_cmp_gt_u32 vcc, 4, v61
  s_cbranch_vccz L_h_mlwd
  s_sleep 8
  s_branch L_h_mlw
L_h_mlwd:
  s_waitcnt lgkmcnt(0)
  s_mov_b32 s56, 200000
  s_cmp_eq_u32 s3, 0
  s_cbranch_scc0 L_h_noml
  v_mov_b32 v19, 0
  ds_read_b128 v[20:23], v19 offset:2560
  ds_read_b128 v[24:27], v19 offset:2576
  s_mov_b32 s57, 1035512379
  s_waitcnt lgkmcnt(0)
  v_max3_f32 v28, v20, v22, v24
  v_max_f32 v28, v28, v26
  v_sub_f32 v29, v20, v28
  v_sub_f32 v30, v22, v28
  v_sub_f32 v31, v24, v28
  v_sub_f32 v32, v26, v28
  v_mul_f32 v29, s57, v29
  v_mul_f32 v30, s57, v30
  v_mul_f32 v31, s57, v31
  v_mul_f32 v32, s57, v32
  v_exp_f32 v29, v29
  v_exp_f32 v30, v30
  v_exp_f32 v31, v31
  v_exp_f32 v32, v32
  v_mul_f32 v9, v29, v21
  v_fmac_f32 v9, v30, v23
  v_fmac_f32 v9, v31, v25
  v_fmac_f32 v9, v32, v27
  v_mov_b32 v8, v28
  s_lshl_b32 s58, s34, 7
  s_add_u32 s58, s58, 196608
  s_lshl_b32 s59, s32, 4
  s_add_u32 s59, s59, s58
  v_mov_b32 v18, 0
  s_mov_b64 exec, 1
  buffer_store_dwordx4 v[8:11], v18, s[36:39], s59 offen sc1
  s_mov_b64 exec, -1
L_h_noml:
  s_cmp_eq_u32 s48, 2
  s_cbranch_scc0 L_h_nof2
  v_lshrrev_b32 v1, 3, v0
  v_mul_lo_u32 v2, v1, s49
  v_and_b32 v1, 7, v0
  v_lshlrev_b32 v1, 4, v1
  v_add3_u32 v2, v2, v1, s44
  s_mul_i32 s57, s3, 112
  s_add_u32 s57, s57, s45
  s_mul_i32 s57, s57, s49
  s_lshl_b32 s58, s49, 3
  s_mul_i32 s59, s3, 14336
  s_add_u32 s59, s59, 24576
  s_add_u32 m0, s59, 0
  s_nop 0
  buffer_load_dwordx4 v2, s[40:43], s57 offen nt lds
  s_add_u32 m0, s59, 1024
  s_add_u32 s57, s57, s58
  buffer_load_dwordx4 v2, s[40:43], s57 offen nt lds
  s_add_u32 m0, s59, 2048
  s_add_u32 s57, s57, s58
  buffer_load_dwordx4 v2, s[40:43], s57 offen nt lds
  s_add_u32 m0, s59, 3072
  s_add_u32 s57, s57, s58
  buffer_load_dwordx4 v2, s[40:43], s57 offen nt lds
  s_add_u32 m0, s59, 4096
  s_add_u32 s57, s57, s58
  buffer_load_dwordx4 v2, s[40:43], s57 offen nt lds
  s_add_u32 m0, s59, 5120
  s_add_u32 s57, s57, s58
  buffer_load_dwordx4 v2, s[40:43], s57 offen nt lds
  s_add_u32 m0, s59, 6144
  s_add_u32 s57, s57, s58
  buffer_load_dwordx4 v2, s[40:43], s57 offen nt lds
  s_add_u32 m0, s59, 7168
  s_add_u32 s57, s57, s58
  buffer_load_dwordx4 v2, s[40:43], s57 offen nt lds
  s_add_u32 m0, s59, 8192
  s_add_u32 s57, s57, s58
  buffer_load_dwordx4 v2, s[40:43], s57 offen nt lds
  s_add_u32 m0, s59, 9216
  s_add_u32 s57, s57, s58
  buffer_load_dwordx4 v2, s[40:43], s57 offen nt lds
  s_add_u32 m0, s59, 10240
  s_add_u32 s57, s57, s58
  buffer_load_dwordx4 v2, s[40:43], s57 offen nt lds
  s_add_u32 m0, s59, 11264
  s_add_u32 s57, s57, s58
  buffer_load_dwordx4 v2, s[40:43], s57 offen nt lds
  s_add_u32 m0, s59, 12288
  s_add_u32 s57, s57, s58
  buffer_load_dwordx4 v2, s[40:43], s57 offen nt lds
  s_add_u32 m0, s59, 13312
  s_add_u32 s57, s57, s58
  buffer_load_dwordx4 v2, s[40:43], s57 offen nt lds
  s_lshl_b32 s57, s3, 6
  v_add_u32 v18, s57, v0
  v_cmp_le_u32 vcc, 112, v18
  v_subrev_u32 v19, 112, v18
  s_nop 0
  v_cndmask_b32 v19, v18, v19, vcc
  v_mov_b32 v20, 0
  v_mov_b32 v21, 1
  v_cndmask_b32 v20, v20, v21, vcc
  v_lshlrev_b32 v21, 13, v20
  v_lshlrev_b32 v22, 4, v19
  v_add_u32 v21, v21, v22
  v_mul_u32_u24 v20, 896, v20
  v_lshlrev_b32 v22, 3, v19
  v_add_u32 v19, v20, v22
  s_mul_i32 s58, s63, 1792
  s_add_u32 s58, s58, 131072
  s_add_u32 s59, s58, 16384
  v_cmp_gt_u32 vcc, 224, v18
  s_and_b64 exec, exec, vcc
L_poll7:
  buffer_load_dwordx4 v[24:27], v21, s[36:39], s58 offen sc1
  buffer_load_dwordx4 v[28:31], v21, s[36:39], s59 offen sc1
  s_sub_i32 s56, s56, 1
  s_cmp_lt_i32 s56, 1
  s_cbranch_scc1 L_polld8
  s_waitcnt vmcnt(0)
  v_xor_b32 v60, s54, v26
  v_xor_b32 v61, s55, v27
  v_or_b32 v60, v60, v61
  v_xor_b32 v62, s54, v30
  v_xor_b32 v61, s55, v31
  v_or3_b32 v60, v60, v61, v62
  v_cmp_ne_u32 vcc, 0, v60
  s_cbranch_vccz L_polld8
  s_sleep 32
  s_branch L_poll7
L_polld8:
  s_waitcnt vmcnt(0)
  s_mov_b32 s57, 3216550459
  v_lshlrev_b32 v32, 16, v24
  v_and_b32 v33, 0xffff0000, v24
  v_mul_f32 v32, s57, v32
  v_mul_f32 v33, s57, v33
  v_exp_f32 v32, v32
  v_exp_f32 v33, v33
  v_add_f32 v32, 1.0, v32
  v_add_f32 v33, 1.0, v33
  v_rcp_f32 v32, v32
  v_rcp_f32 v33, v33
  v_lshlrev_b32 v34, 16, v28
  v_and_b32 v35, 0xffff0000, v28
  v_cvt_pk_bf16_f32 v32, v32, v33
  v_lshlrev_b32 v33, 16, v32
  v_and_b32 v32, 0xffff0000, v32
  v_mul_f32 v33, v33, v34
  v_mul_f32 v32, v32, v35
  v_cvt_pk_bf16_f32 v36, v33, v32
  v_lshlrev_b32 v32, 16, v25
  v_and_b32 v33, 0xffff0000, v25
  v_mul_f32 v32, s57, v32
  v_mul_f32 v33, s57, v33
  v_exp_f32 v32, v32
  v_exp_f32 v33, v33
  v_add_f32 v32, 1.0, v32
  v_add_f32 v33, 1.0, v33
  v_rcp_f32 v32, v32
  v_rcp_f32 v33, v33
  v_lshlrev_b32 v34, 16, v29
  v_and_b32 v35, 0xffff0000, v29
  v_cvt_pk_bf16_f32 v32, v32, v33
  v_lshlrev_b32 v33, 16, v32
  v_and_b32 v32, 0xffff0000, v32
  v_mul_f32 v33, v33, v34
  v_mul_f32 v32, v32, v35
  v_cvt_pk_bf16_f32 v37, v33, v32
  ds_write_b64 v19, v[36:37] offset:0
  s_mov_b64 exec, -1
  s_waitcnt vmcnt(0) lgkmcnt(0)
  v_mov_b32 v60, 0
  v_mov_b32 v61, 1
  s_mov_b64 exec, 1
  ds_add_u32 v60, v61 offset:2696
  s_mov_b64 exec, -1
L_hs9:
  ds_read_b32 v61, v60 offset:2696
  s_sub_i32 s56, s56, 1
  s_cmp_lt_i32 s56, 1
  s_cbranch_scc1 L_hsd10
  s_waitcnt lgkmcnt(0)
  v_cmp_gt_u32 vcc, 4, v61
  s_cbranch_vccnz L_hs9
L_hsd10:
  s_waitcnt lgkmcnt(0)
  ds_read_b128 v[64:67], v5 offset:0
  ds_read_b64_tr_b16 v[184:185], v17 offset:0
  ds_read_b64_tr_b16 v[186:187], v17 offset:512
  ds_read_b128 v[68:71], v5 offset:64
  ds_read_b64_tr_b16 v[188:189], v17 offset:4096
  ds_read_b64_tr_b16 v[190:191], v17 offset:4608
  ds_read_b128 v[72:75], v5 offset:128
  ds_read_b64_tr_b16 v[192:193], v17 offset:8192
  ds_read_b64_tr_b16 v[194:195], v17 offset:8704
  ds_read_b128 v[76:79], v5 offset:192
  ds_read_b64_tr_b16 v[196:197], v17 offset:12288
  ds_read_b64_tr_b16 v[198:199], v17 offset:12800
  ds_read_b128 v[80:83], v5 offset:256
  ds_read_b64_tr_b16 v[200:201], v17 offset:16384
  ds_read_b64_tr_b16 v[202:203], v17 offset:16896
  s_waitcnt lgkmcnt(12)
  v_mfma_f32_16x16x32_bf16 v[12:15], v[64:67], v[184:187], 0
  ds_read_b128 v[84:87], v5 offset:320
  ds_read_b64_tr_b16 v[204:205], v17 offset:20480
  ds_read_b64_tr_b16 v[206:207], v17 offset:20992
  s_waitcnt lgkmcnt(12)
  v_mfma_f32_16x16x32_bf16 v[12:15], v[68:71], v[188:191], v[12:15]
  ds_read_b128 v[88:91], v5 offset:384
  ds_read_b64_tr_b16 v[208:209], v17 offset:24576
  ds_read_b64_tr_b16 v[210:211], v17 offset:25088
  s_waitcnt lgkmcnt(12)
  v_mfma_f32_16x16x32_bf16 v[12:15], v[72:75], v[192:195], v[12:15]
  ds_read_b128 v[92:95], v5 offset:448
  ds_read_b64_tr_b16 v[212:213], v17 offset:28672
  ds_read_b64_tr_b16 v[214:215], v17 offset:29184
  s_waitcnt lgkmcnt(12)
  v_mfma_f32_16x16x32_bf16 v[12:15], v[76:79], v[196:199], v[12:15]
  ds_read_b128 v[96:99], v5 offset:512
  ds_read_b64_tr_b16 v[216:217], v17 offset:32768
  ds_read_b64_tr_b16 v[218:219], v17 offset:33280
  s_waitcnt lgkmcnt(12)
  v_mfma_f32_16x16x32_bf16 v[12:15], v[80:83], v[200:203], v[12:15]
  ds_read_b128 v[100:103], v5 offset:576
  ds_read_b64_tr_b16 v[220:221], v17 offset:36864
  ds_read_b64_tr_b16 v[222:223], v17 offset:37376
  s_waitcnt lgkmcnt(12)
  v_mfma_f32_16x16x32_bf16 v[12:15], v[84:87], v[204:207], v[12:15]
  ds_read_b128 v[104:107], v5 offset:640
  ds_read_b64_tr_b16 v[224:225], v17 offset:40960
  ds_read_b64_tr_b16 v[226:227], v17 offset:41472
  s_waitcnt lgkmcnt(12)
  v_mfma_f32_16x16x32_bf16 v[12:15], v[88:91], v[208:211], v[12:15]
  ds_read_b128 v[108:111], v5 offset:704
  ds_read_b64_tr_b16 v[228:229], v17 offset:45056
  ds_read_b64_tr_b16 v[230:231], v17 offset:45568
  s_waitcnt lgkmcnt(12)
  v_mfma_f32_16x16x32_bf16 v[12:15], v[92:95], v[212:215], v[12:15]
  ds_read_b128 v[112:115], v5 offset:768
  ds_read_b64_tr_b16 v[232:233], v17 offset:49152
  ds_read_b64_tr_b16 v[234:235], v17 offset:49664
  s_waitcnt lgkmcnt(12)
  v_mfma_f32_16x16x32_bf16 v[12:15], v[96:99], v[216:219], v[12:15]
  ds_read_b128 v[116:119], v5 offset:832
  ds_read_b64_tr_b16 v[236:237], v17 offset:53248
  ds_read_b64_tr_b16 v[238:239], v17 offset:53760
  s_waitcnt lgkmcnt(12)
  v_mfma_f32_16x16x32_bf16 v[12:15], v[100:103], v[220:223], v[12:15]
  s_waitcnt lgkmcnt(9)
  v_mfma_f32_16x16x32_bf16 v[12:15], v[104:107], v[224:227], v[12:15]
  s_waitcnt lgkmcnt(6)
  v_mfma_f32_16x16x32_bf16 v[12:15], v[108:111], v[228:231], v[12:15]
  s_waitcnt lgkmcnt(3)
  v_mfma_f32_16x16x32_bf16 v[12:15], v[112:115], v[232:235], v[12:15]
  s_waitcnt lgkmcnt(0)
  v_mfma_f32_16x16x32_bf16 v[12:15], v[116:119], v[236:239], v[12:15]
  v_lshrrev_b32 v18, 4, v0
  v_lshlrev_b32 v18, 14, v18
  v_bfe_u32 v19, v0, 1, 3
  v_lshlrev_b32 v19, 4, v19
  v_add_u32 v18, v18, v19
  s_nop 2
  v_mov_b32 v8, v12
  v_mov_b32_dpp v9, v12 row_shl:1 row_mask:0xf bank_mask:0xf
  s_lshl_b32 s58, s3, 7
  s_add_u32 s58, s58, s62
  s_mov_b32 exec_lo, 0x55555555
  s_mov_b32 exec_hi, 0
  buffer_store_dwordx4 v[8:11], v18, s[36:39], s58 offen sc1
  s_mov_b64 exec, -1
L_h_nof2:
  s_cmp_eq_u32 s3, 0
  s_cbranch_scc0 L_h_noml2
  s_mov_b32 s56, 200000
  v_mov_b32 v60, 0
L_h_lw:
  ds_read_b32 v61, v60 offset:2712
  s_sub_i32 s56, s56, 1
  s_cmp_lt_i32 s56, 1
  s_cbranch_scc1 L_h_lwd
  s_waitcnt lgkmcnt(0)
  v_cmp_gt_u32 vcc, 1, v61
  s_cbranch_vccz L_h_lwd
  s_sleep 8
  s_branch L_h_lw
L_h_lwd:
  s_waitcnt lgkmcnt(0)
  s_mov_b32 s56, 200000
  v_mov_b32 v19, 0
  ds_read_b128 v[20:23], v19 offset:2560
  ds_read_b128 v[24:27], v19 offset:2576
  v_and_b32 v18, 7, v0
  v_lshlrev_b32 v18, 4, v18
  s_lshl_b32 s60, s34, 7
  s_add_u32 s60, s60, 196608
  s_waitcnt lgkmcnt(0)
L_poll11:
  buffer_load_dwordx4 v[32:35], v18, s[36:39], s60 offen sc1
  s_sub_i32 s56, s56, 1
  s_cmp_lt_i32 s56, 1
  s_cbranch_scc1 L_polld12
  s_waitcnt vmcnt(0)
  v_xor_b32 v60, s54, v34
  v_xor_b32 v61, s55, v35
  v_or_b32 v60, v60, v61
  v_cmp_ne_u32 vcc, 0, v60
  s_cbranch_vccz L_polld12
  s_sleep 8
  s_branch L_poll11
L_polld12:
  s_waitcnt vmcnt(0)
  v_mov_b32 v28, v32
  s_nop 1
  v_max_f32_dpp v28, v28, v28 row_ror:4 row_mask:0xf bank_mask:0xf
  s_nop 1
  v_max_f32_dpp v28, v28, v28 row_ror:2 row_mask:0xf bank_mask:0xf
  s_nop 1
  v_max_f32_dpp v28, v28, v28 row_ror:1 row_mask:0xf bank_mask:0xf
  s_mov_b32 s57, 1035512379
  v_sub_f32 v29, v32, v28
  v_mul_f32 v29, s57, v29
  v_exp_f32 v29, v29
  s_nop 0
  v_mul_f32 v29, v29, v33
  s_nop 1
  v_add_f32_dpp v29, v29, v29 row_ror:4 row_mask:0xf bank_mask:0xf
  s_nop 1
  v_add_f32_dpp v29, v29, v29 row_ror:2 row_mask:0xf bank_mask:0xf
  s_nop 1
  v_add_f32_dpp v29, v29, v29 row_ror:1 row_mask:0xf bank_mask:0xf
  v_rcp_f32 v29, v29
  v_sub_f32 v30, v20, v28
  v_mul_f32 v30, s57, v30
  v_exp_f32 v30, v30
  s_nop 0
  v_mul_f32 v36, v30, v29
  v_sub_f32 v30, v22, v28
  v_mul_f32 v30, s57, v30
  v_exp_f32 v30, v30
  s_nop 0
  v_mul_f32 v37, v30, v29
  v_sub_f32 v30, v24, v28
  v_mul_f32 v30, s57, v30
  v_exp_f32 v30, v30
  s_nop 0
  v_mul_f32 v38, v30, v29
  v_sub_f32 v30, v26, v28
  v_mul_f32 v30, s57, v30
  v_exp_f32 v30, v30
  s_nop 0
  v_mul_f32 v39, v30, v29
  s_mov_b64 exec, 1
  ds_write_b128 v19, v[36:39] offset:2624
  s_mov_b64 exec, -1
L_h_noml2:
  v_lshrrev_b32 v241, 3, v0
  v_lshlrev_b32 v241, 9, v241
  v_and_b32 v26, 7, v0
  v_lshlrev_b32 v26, 4, v26
  v_add_u32 v241, v241, v26
  v_and_b32 v243, 0x7ff, v241
  s_mov_b32 s45, 0
L_h_b3:
  s_mov_b32 s56, 200000
  v_mov_b32 v60, 0
L_h_ww:
  ds_read_b32 v61, v60 offset:2716
  s_sub_i32 s56, s56, 1
  s_cmp_lt_i32 s56, 1
  s_cbranch_scc1 L_h_wwd
  s_waitcnt lgkmcnt(0)
  v_cmp_gt_u32 vcc, 1, v61
  s_cbranch_vccz L_h_wwd
  s_sleep 4
  s_branch L_h_ww
L_h_wwd:
  s_waitcnt lgkmcnt(0)
  s_cmp_eq_u32 s32, 7
  s_cbranch_scc1 L_h_nowo
  s_mov_b32 s96, s12
  s_mov_b32 s97, s13
  s_mov_b32 s98, 3670016
  s_mov_b32 s99, 0x20000
  v_lshrrev_b32 v1, 3, v0
  v_mul_u32_u24 v2, 896, v1
  v_and_b32 v1, 7, v0
  v_lshlrev_b32 v1, 4, v1
  s_lshl_b32 s57, s32, 7
  v_add3_u32 v2, v2, v1, s57
  s_lshl_b32 s57, s33, 8
  s_lshl_b32 s58, s30, 7
  s_add_u32 s57, s57, s58
  s_lshl_b32 s58, s3, 5
  s_add_u32 s57, s57, s58
  s_mul_i32 s57, s57, 896
  s_lshl_b32 s59, s3, 12
  s_add_u32 s59, s59, 8192
  s_add_u32 m0, s59, 0
  s_nop 0
  buffer_load_dwordx4 v2, s[96:99], s57 offen nt lds
  s_add_u32 m0, s59, 1024
  s_add_u32 s57, s57, 7168
  buffer_load_dwordx4 v2, s[96:99], s57 offen nt lds
  s_add_u32 m0, s59, 2048
  s_add_u32 s57, s57, 7168
  buffer_load_dwordx4 v2, s[96:99], s57 offen nt lds
  s_add_u32 m0, s59, 3072
  s_add_u32 s57, s57, 7168
  buffer_load_dwordx4 v2, s[96:99], s57 offen nt lds
L_h_nowo:
  v_and_b32 v26, 31, v0
  s_lshl_b32 s57, s3, 5
  v_add_u32 v26, s57, v26
  v_lshlrev_b32 v27, 4, v26
  v_lshlrev_b32 v26, 3, v26
  s_lshl_b32 s59, s34, 3
  s_add_u32 s59, s59, s32
  s_lshl_b32 s59, s59, 11
  s_add_u32 s59, s59, 589824
  v_lshrrev_b32 v29, 5, v0
  v_lshlrev_b32 v28, 8, v29
  v_lshlrev_b32 v29, 18, v29
  v_bfe_u32 v30, v0, 4, 1
  v_lshlrev_b32 v30, 13, v30
  v_and_b32 v31, 15, v0
  v_lshlrev_b32 v32, 4, v31
  v_add3_u32 v29, v29, v30, v32
  v_lshlrev_b32 v31, 2, v31
  s_lshl_b32 s57, s3, 6
  v_add3_u32 v28, v28, v31, s57
  s_lshl_b32 s60, s33, 14
  s_lshl_b32 s57, s30, 10
  s_add_u32 s60, s60, s57
  s_lshl_b32 s57, s3, 8
  s_add_u32 s60, s60, s57
  s_add_u32 s60, s60, 589824
  v_bfe_u32 v242, v0, 2, 1
  v_lshlrev_b32 v242, 8, v242
  v_add_u32 v242, v242, v7
  v_lshrrev_b32 v240, 4, v0
  v_lshlrev_b32 v240, 17, v240
  v_bfe_u32 v30, v0, 1, 3
  v_lshlrev_b32 v30, 4, v30
  v_add_u32 v240, v240, v30
  s_lshl_b32 s63, s32, 5
  s_lshl_b32 s57, s33, 1
  s_add_u32 s63, s63, s57
  s_add_u32 s63, s63, s30
  s_lshl_b32 s63, s63, 9
  s_lshl_b32 s57, s3, 7
  s_add_u32 s63, s63, s57
  s_add_u32 s63, s63, 327680
  v_mov_b32 v19, 0
  s_mov_b32 s56, 200000
  s_waitcnt lgkmcnt(0)
  s_waitcnt vmcnt(0)
  s_barrier
  ds_read_b128 v[180:183], v19 offset:2624
  ds_read_b64 v[32:33], v26 offset:4096
  ds_read_b64 v[34:35], v26 offset:5120
  ds_read_b64 v[36:37], v26 offset:6144
  ds_read_b64 v[38:39], v26 offset:7168
  s_waitcnt lgkmcnt(3)
  v_mul_f32 v8, v180, v32
  v_mul_f32 v9, v180, v33
  s_waitcnt lgkmcnt(2)
  v_fmac_f32 v8, v181, v34
  v_fmac_f32 v9, v181, v35
  s_waitcnt lgkmcnt(1)
  v_fmac_f32 v8, v182, v36
  v_fmac_f32 v9, v182, v37
  s_waitcnt lgkmcnt(0)
  v_fmac_f32 v8, v183, v38
  v_fmac_f32 v9, v183, v39
  s_mov_b32 exec_lo, 0xffffffff
  s_mov_b32 exec_hi, 0
  buffer_store_dwordx4 v[8:11], v27, s[36:39], s59 offen sc1
  s_mov_b64 exec, -1
  s_cmp_eq_u32 s32, 7
  s_cbranch_scc1 L_h_exit
  v_add_u32 v16, 8192, v6
  ds_read_b64_tr_b16 v[128:129], v16 offset:0
  ds_read_b64_tr_b16 v[130:131], v16 offset:512
  ds_read_b64_tr_b16 v[132:133], v16 offset:4096
  ds_read_b64_tr_b16 v[134:135], v16 offset:4608
  ds_read_b64_tr_b16 v[136:137], v16 offset:8192
  ds_read_b64_tr_b16 v[138:139], v16 offset:8704
  ds_read_b64_tr_b16 v[140:141], v16 offset:12288
  ds_read_b64_tr_b16 v[142:143], v16 offset:12800
  s_cmp_eq_u32 s61, 1
  s_cbranch_scc0 L_h_nob
  s_lshl_b32 s57, s49, 3
  s_add_u32 s57, s57, s50
  s_lshl_b32 s45, s57, 11
  s_lshl_b32 s57, s100, 7
  s_add_u32 s45, s45, s57
  s_add_u32 s45, s45, 262144
  buffer_load_dwordx4 v[48:51], v243, s[36:39], s45 offen sc1
L_h_nob:
  s_add_u32 s57, s60, 2048
  s_add_u32 s58, s60, 4096
  s_add_u32 s59, s60, 6144
L_poll13:
  buffer_load_dwordx4 v[32:35], v29, s[36:39], s60 offen sc1
  buffer_load_dwordx4 v[36:39], v29, s[36:39], s57 offen sc1
  buffer_load_dwordx4 v[40:43], v29, s[36:39], s58 offen sc1
  buffer_load_dwordx4 v[44:47], v29, s[36:39], s59 offen sc1
  s_sub_i32 s56, s56, 1
  s_cmp_lt_i32 s56, 1
  s_cbranch_scc1 L_polld14
  s_waitcnt vmcnt(0)
  v_xor_b32 v60, s54, v34
  v_xor_b32 v61, s55, v35
  v_or_b32 v60, v60, v61
  v_xor_b32 v62, s54, v38
  v_xor_b32 v61, s55, v39
  v_or3_b32 v60, v60, v61, v62
  v_xor_b32 v62, s54, v42
  v_xor_b32 v61, s55, v43
  v_or3_b32 v60, v60, v61, v62
  v_xor_b32 v62, s54, v46
  v_xor_b32 v61, s55, v47
  v_or3_b32 v60, v60, v61, v62
  v_cmp_ne_u32 vcc, 0, v60
  s_cbranch_vccnz L_poll13
L_polld14:
  s_waitcnt vmcnt(0)
  v_add_f32 v32, v32, v36
  v_add_f32 v33, v33, v37
  v_add_f32 v40, v40, v44
  v_add_f32 v41, v41, v45
  v_add_f32 v32, v32, v40
  v_add_f32 v33, v33, v41
  v_mov_b32 v40, v32
  v_mov_b32 v41, v33
  s_nop 0
  v_permlane16_swap_b32 v32, v40
  v_permlane16_swap_b32 v33, v41
  v_add_f32 v32, v32, v40
  v_add_f32 v33, v33, v41
  v_cvt_pk_bf16_f32 v32, v32, v33
  ds_write_b32 v28, v32 offset:3072
  s_waitcnt lgkmcnt(0)
  s_barrier
  ds_read_b128 v[64:67], v242 offset:3072
  ds_read_b128 v[68:71], v242 offset:3136
  ds_read_b128 v[72:75], v242 offset:3200
  ds_read_b128 v[76:79], v242 offset:3264
  s_waitcnt lgkmcnt(3)
  v_mfma_f32_16x16x32_bf16 v[12:15], v[64:67], v[128:131], 0
  s_waitcnt lgkmcnt(2)
  v_mfma_f32_16x16x32_bf16 v[12:15], v[68:71], v[132:135], v[12:15]
  s_waitcnt lgkmcnt(1)
  v_mfma_f32_16x16x32_bf16 v[12:15], v[72:75], v[136:139], v[12:15]
  s_waitcnt lgkmcnt(0)
  v_mfma_f32_16x16x32_bf16 v[12:15], v[76:79], v[140:143], v[12:15]
  s_nop 7
  v_mov_b32 v8, v12
  v_mov_b32_dpp v9, v12 row_shl:1 row_mask:0xf bank_mask:0xf
  s_mov_b32 exec_lo, 0x55555555
  s_mov_b32 exec_hi, 0
  buffer_store_dwordx4 v[8:11], v240, s[36:39], s63 offen sc1
  s_mov_b64 exec, -1
  s_cmp_eq_u32 s61, 1
  s_cbranch_scc0 L_h_exit
  s_mov_b32 s40, s24
  s_mov_b32 s41, s25
  s_mov_b32 s42, 1792
  s_mov_b32 s43, 0x20000
  v_xor_b32 v60, s54, v50
  v_xor_b32 v61, s55, v51
  v_or_b32 v60, v60, v61
  v_cmp_ne_u32 vcc, 0, v60
  s_cbranch_vccz L_h_bok
L_poll15:
  buffer_load_dwordx4 v[48:51], v243, s[36:39], s45 offen sc1
  s_sub_i32 s56, s56, 1
  s_cmp_lt_i32 s56, 1
  s_cbranch_scc1 L_polld16
  s_waitcnt vmcnt(0)
  v_xor_b32 v60, s54, v50
  v_xor_b32 v61, s55, v51
  v_or_b32 v60, v60, v61
  v_cmp_ne_u32 vcc, 0, v60
  s_cbranch_vccnz L_poll15
L_polld16:
  s_waitcnt vmcnt(0)
L_h_bok:
  v_add_f32_dpp v48, v48, v48 row_ror:8 row_mask:0xf bank_mask:0xf
  v_add_f32_dpp v49, v49, v49 row_ror:8 row_mask:0xf bank_mask:0xf
  v_mov_b32 v40, v48
  v_mov_b32 v41, v49
  s_nop 0
  v_permlane16_swap_b32 v48, v40
  v_permlane16_swap_b32 v49, v41
  v_add_f32 v48, v48, v40
  v_add_f32 v49, v49, v41
  v_cvt_pk_bf16_f32 v176, v48, v49
  s_lshl_b32 s57, s49, 3
  s_add_u32 s57, s57, s50
  s_lshl_b32 s58, s57, 14
  s_lshl_b32 s59, s100, 7
  s_add_u32 s58, s58, s59
  s_add_u32 s58, s58, 327680
  s_add_u32 s59, s58, 4096
  s_add_u32 s60, s58, 8192
  s_add_u32 s62, s58, 12288
L_poll17:
  buffer_load_dwordx4 v[32:35], v241, s[36:39], s58 offen sc1
  buffer_load_dwordx4 v[36:39], v241, s[36:39], s59 offen sc1
  buffer_load_dwordx4 v[40:43], v241, s[36:39], s60 offen sc1
  buffer_load_dwordx4 v[44:47], v241, s[36:39], s62 offen sc1
  s_sub_i32 s56, s56, 1
  s_cmp_lt_i32 s56, 1
  s_cbranch_scc1 L_polld18
  s_waitcnt vmcnt(0)
  v_xor_b32 v60, s54, v34
  v_xor_b32 v61, s55, v35
  v_or_b32 v60, v60, v61
  v_xor_b32 v62, s54, v38
  v_xor_b32 v61, s55, v39
  v_or3_b32 v60, v60, v61, v62
  v_xor_b32 v62, s54, v42
  v_xor_b32 v61, s55, v43
  v_or3_b32 v60, v60, v61, v62
  v_xor_b32 v62, s54, v46
  v_xor_b32 v61, s55, v47
  v_or3_b32 v60, v60, v61, v62
  v_cmp_ne_u32 vcc, 0, v60
  s_cbranch_vccnz L_poll17
L_polld18:
  s_waitcnt vmcnt(0)
  v_add_f32 v32, v32, v36
  v_add_f32 v33, v33, v37
  v_add_f32 v40, v40, v44
  v_add_f32 v41, v41, v45
  v_add_f32 v42, v32, v40
  v_add_f32 v43, v33, v41
  s_nop 0
  v_add_f32_dpp v42, v42, v42 row_ror:8 row_mask:0xf bank_mask:0xf
  v_add_f32_dpp v43, v43, v43 row_ror:8 row_mask:0xf bank_mask:0xf
  v_mov_b32 v40, v42
  v_mov_b32 v41, v43
  s_nop 0
  v_permlane16_swap_b32 v42, v40
  v_permlane16_swap_b32 v43, v41
  v_add_f32 v42, v42, v40
  v_add_f32 v43, v43, v41
  v_mov_b32 v40, v42
  v_mov_b32 v41, v43
  s_nop 0
  v_permlane32_swap_b32 v42, v40
  v_permlane32_swap_b32 v43, v41
  v_add_f32 v42, v42, v40
  v_add_f32 v43, v43, v41
  v_cvt_pk_bf16_f32 v42, v42, v43
  v_lshlrev_b32 v44, 16, v42
  v_and_b32 v45, 0xffff0000, v42
  v_lshlrev_b32 v46, 16, v176
  v_and_b32 v47, 0xffff0000, v176
  v_mul_f32 v44, v178, v44
  v_mul_f32 v45, v178, v45
  v_mul_f32 v46, v179, v46
  v_mul_f32 v47, v179, v47
  v_cvt_pk_bf16_f32 v44, v44, v45
  v_cvt_pk_bf16_f32 v46, v46, v47
  v_lshlrev_b32 v45, 16, v44
  v_and_b32 v44, 0xffff0000, v44
  v_lshlrev_b32 v47, 16, v46
  v_and_b32 v46, 0xffff0000, v46
  v_add_f32 v45, v45, v47
  v_add_f32 v44, v44, v46
  v_cvt_pk_bf16_f32 v44, v45, v44
  s_mul_i32 s57, s49, 896
  s_lshl_b32 s58, s50, 7
  s_add_u32 s57, s57, s58
  s_lshl_b32 s58, s100, 5
  s_add_u32 s57, s57, s58
  v_lshlrev_b32 v45, 2, v0
  s_mov_b64 exec, 0xff
  buffer_store_dword v44, v45, s[40:43], s57 offen
  s_mov_b64 exec, -1
  s_or_b32 s57, s35, s100
  s_cmp_eq_u32 s57, 0
  s_cbranch_scc0 L_h_exit
  v_mov_b32 v18, 0
  s_mov_b64 exec, 1
  buffer_store_dwordx2 v[10:11], v18, s[36:39], 0 offen sc1
  s_mov_b64 exec, -1
L_h_exit:
  s_endpgm
L_stream:
  s_sub_u32 s46, s3, 4
  s_lshl_b32 s47, s34, 3
  s_add_u32 s47, s47, s32
  s_lshl_b32 s47, s47, 19
  s_lshl_b32 s48, s46, 12
  s_add_u32 s47, s47, s48
  v_lshlrev_b32 v1, 4, v0
  v_add_u32 v1, s47, v1
  s_lshr_b32 s40, s34, 0
  s_and_b32 s40, s40, 3
  s_lshl_b32 s40, s40, 17
  s_and_b32 s40, s40, 0x7ffff
  s_waitcnt lgkmcnt(0)
  s_mov_b32 s36, s6
  s_mov_b32 s37, s7
  s_mov_b32 s38, 134217728
  s_mov_b32 s39, 0x20000
  s_barrier
  buffer_load_dwordx4 v[128:131], v1, s[36:39], s40 offen offset:0 nt
  buffer_load_dwordx4 v[132:135], v1, s[36:39], s40 offen offset:1024 nt
  buffer_load_dwordx4 v[136:139], v1, s[36:39], s40 offen offset:2048 nt
  buffer_load_dwordx4 v[140:143], v1, s[36:39], s40 offen offset:3072 nt
  s_add_u32 s40, s40, 16384
  s_and_b32 s40, s40, 0x7ffff
  buffer_load_dwordx4 v[144:147], v1, s[36:39], s40 offen offset:0 nt
  s_waitcnt vmcnt(4)
  buffer_load_dwordx4 v[148:151], v1, s[36:39], s40 offen offset:1024 nt
  s_waitcnt vmcnt(4)
  buffer_load_dwordx4 v[152:155], v1, s[36:39], s40 offen offset:2048 nt
  s_waitcnt vmcnt(4)
  buffer_load_dwordx4 v[156:159], v1, s[36:39], s40 offen offset:3072 nt
  s_add_u32 s40, s40, 16384
  s_and_b32 s40, s40, 0x7ffff
  v_and_b32 v10, 15, v0
  v_lshrrev_b32 v11, 3, v10
  v_bfe_u32 v12, v0, 4, 1
  v_bfe_u32 v13, v0, 1, 2
  v_cmp_eq_u32 vcc, v11, v12
  v_mov_b32 v14, 7
  s_nop 0
  v_cndmask_b32 v13, v14, v13, vcc
  v_and_b32 v14, 1, v0
  v_cmp_eq_u32 vcc, 1, v14
  v_mov_b32 v15, 0x0c0c0100
  v_mov_b32 v16, 0x01000c0c
  v_cndmask_b32 v15, v15, v16, vcc
  v_mov_b32 v16, 0x0c0c0302
  v_mov_b32 v17, 0x03020c0c
  v_cndmask_b32 v16, v16, v17, vcc
  v_mov_b32 v17, 0x0c0c0c0c
  v_cmp_eq_u32 vcc, 0, v13
  s_nop 1
  v_cndmask_b32 v48, v17, v15, vcc
  v_cndmask_b32 v52, v17, v16, vcc
  v_cmp_eq_u32 vcc, 1, v13
  s_nop 1
  v_cndmask_b32 v49, v17, v15, vcc
  v_cndmask_b32 v53, v17, v16, vcc
  v_cmp_eq_u32 vcc, 2, v13
  s_nop 1
  v_cndmask_b32 v50, v17, v15, vcc
  v_cndmask_b32 v54, v17, v16, vcc
  v_cmp_eq_u32 vcc, 3, v13
  s_nop 1
  v_cndmask_b32 v51, v17, v15, vcc
  v_cndmask_b32 v55, v17, v16, vcc
  v_lshrrev_b32 v72, 5, v0
  v_lshlrev_b32 v72, 7, v72
  v_and_b32 v10, 31, v0
  v_lshlrev_b32 v73, 4, v10
  s_mov_b32 s42, 0xcccccccc
  s_mov_b32 s43, 0xcccccccc
  s_mov_b32 s44, 0xaaaaaaaa
  s_mov_b32 s45, 0xaaaaaaaa
  v_bfe_u32 v10, v0, 3, 1
  v_lshlrev_b32 v74, 9, v10
  v_lshrrev_b32 v10, 4, v0
  v_lshlrev_b32 v10, 7, v10
  v_add_u32 v74, v74, v10
  v_and_b32 v10, 7, v0
  v_lshlrev_b32 v10, 2, v10
  v_add_u32 v74, v74, v10
  s_lshl_b32 s48, s46, 10
  s_add_u32 s48, s48, 4096
  v_add_u32 v74, s48, v74
  s_waitcnt vmcnt(4)
  buffer_load_dwordx4 v[160:163], v1, s[36:39], s40 offen offset:0 nt
  s_waitcnt vmcnt(4)
  buffer_load_dwordx4 v[164:167], v1, s[36:39], s40 offen offset:1024 nt
  s_waitcnt vmcnt(4)
  buffer_load_dwordx4 v[168:171], v1, s[36:39], s40 offen offset:2048 nt
  s_waitcnt vmcnt(4)
  buffer_load_dwordx4 v[172:175], v1, s[36:39], s40 offen offset:3072 nt
  s_add_u32 s40, s40, 16384
  s_and_b32 s40, s40, 0x7ffff
  s_waitcnt vmcnt(4)
  buffer_load_dwordx4 v[176:179], v1, s[36:39], s40 offen offset:0 nt
  s_waitcnt vmcnt(4)
  buffer_load_dwordx4 v[180:183], v1, s[36:39], s40 offen offset:1024 nt
  s_waitcnt vmcnt(4)
  buffer_load_dwordx4 v[184:187], v1, s[36:39], s40 offen offset:2048 nt
  s_waitcnt vmcnt(4)
  buffer_load_dwordx4 v[188:191], v1, s[36:39], s40 offen offset:3072 nt
  s_add_u32 s40, s40, 16384
  s_and_b32 s40, s40, 0x7ffff
  s_waitcnt vmcnt(4)
  buffer_load_dwordx4 v[192:195], v1, s[36:39], s40 offen offset:0 nt
  s_waitcnt vmcnt(4)
  buffer_load_dwordx4 v[196:199], v1, s[36:39], s40 offen offset:1024 nt
  s_waitcnt vmcnt(4)
  buffer_load_dwordx4 v[200:203], v1, s[36:39], s40 offen offset:2048 nt
  s_waitcnt vmcnt(4)
  buffer_load_dwordx4 v[204:207], v1, s[36:39], s40 offen offset:3072 nt
  s_add_u32 s40, s40, 16384
  s_and_b32 s40, s40, 0x7ffff
  s_waitcnt vmcnt(4)
  buffer_load_dwordx4 v[208:211], v1, s[36:39], s40 offen offset:0 nt
  s_waitcnt vmcnt(4)
  buffer_load_dwordx4 v[212:215], v1, s[36:39], s40 offen offset:1024 nt
  s_waitcnt vmcnt(4)
  buffer_load_dwordx4 v[216:219], v1, s[36:39], s40 offen offset:2048 nt
  s_waitcnt vmcnt(4)
  buffer_load_dwordx4 v[220:223], v1, s[36:39], s40 offen offset:3072 nt
  s_add_u32 s40, s40, 16384
  s_and_b32 s40, s40, 0x7ffff
  s_waitcnt vmcnt(4)
  buffer_load_dwordx4 v[224:227], v1, s[36:39], s40 offen offset:0 nt
  s_waitcnt vmcnt(4)
  buffer_load_dwordx4 v[228:231], v1, s[36:39], s40 offen offset:1024 nt
  s_waitcnt vmcnt(4)
  buffer_load_dwordx4 v[232:235], v1, s[36:39], s40 offen offset:2048 nt
  s_waitcnt vmcnt(4)
  buffer_load_dwordx4 v[236:239], v1, s[36:39], s40 offen offset:3072 nt
  s_add_u32 s40, s40, 16384
  s_and_b32 s40, s40, 0x7ffff
  s_waitcnt vmcnt(4)
  buffer_load_dwordx4 v[240:243], v1, s[36:39], s40 offen offset:0 nt
  s_waitcnt vmcnt(4)
  buffer_load_dwordx4 v[244:247], v1, s[36:39], s40 offen offset:1024 nt
  s_waitcnt vmcnt(4)
  buffer_load_dwordx4 v[248:251], v1, s[36:39], s40 offen offset:2048 nt
  s_waitcnt vmcnt(4)
  buffer_load_dwordx4 v[252:255], v1, s[36:39], s40 offen offset:3072 nt
  s_add_u32 s40, s40, 16384
  s_and_b32 s40, s40, 0x7ffff
  s_barrier
  ds_read_b128 v[2:5], v73 offset:2048
  v_mov_b32 v31, 0
  s_mov_b32 s41, 0
  s_waitcnt lgkmcnt(0)
L_kloop:
  s_waitcnt vmcnt(5)
  v_dot2_f32_bf16 v10, v128, v2, 0
  v_dot2_f32_bf16 v11, v132, v2, 0
  v_dot2_f32_bf16 v12, v136, v2, 0
  v_dot2_f32_bf16 v13, v140, v2, 0
  v_dot2c_f32_bf16 v10, v129, v3
  v_dot2c_f32_bf16 v11, v133, v3
  v_dot2c_f32_bf16 v12, v137, v3
  v_dot2c_f32_bf16 v13, v141, v3
  v_dot2c_f32_bf16 v10, v130, v4
  v_dot2c_f32_bf16 v11, v134, v4
  v_dot2c_f32_bf16 v12, v138, v4
  v_dot2c_f32_bf16 v13, v142, v4
  v_dot2c_f32_bf16 v10, v131, v5
  v_dot2c_f32_bf16 v11, v135, v5
  v_dot2c_f32_bf16 v12, v139, v5
  v_dot2c_f32_bf16 v13, v143, v5
  s_waitcnt vmcnt(4)
  buffer_load_dwordx4 v[128:131], v1, s[36:39], s40 offen offset:0 nt
  s_waitcnt vmcnt(4)
  buffer_load_dwordx4 v[132:135], v1, s[36:39], s40 offen offset:1024 nt
  s_waitcnt vmcnt(4)
  buffer_load_dwordx4 v[136:139], v1, s[36:39], s40 offen offset:2048 nt
  s_waitcnt vmcnt(4)
  buffer_load_dwordx4 v[140:143], v1, s[36:39], s40 offen offset:3072 nt
  s_add_u32 s40, s40, 16384
  s_and_b32 s40, s40, 0x7ffff
  v_permlane16_swap_b32 v10, v11
  v_permlane16_swap_b32 v12, v13
  v_add_f32 v10, v10, v11
  v_add_f32 v12, v12, v13
  s_nop 0
  v_add_f32_dpp v14, v10, v10 row_ror:8 row_mask:0xf bank_mask:0x3
  s_nop 1
  v_add_f32_dpp v14, v12, v12 row_ror:8 row_mask:0xf bank_mask:0xc
  s_waitcnt vmcnt(5)
  v_dot2_f32_bf16 v10, v144, v2, 0
  v_dot2_f32_bf16 v11, v148, v2, 0
  v_dot2_f32_bf16 v12, v152, v2, 0
  v_dot2_f32_bf16 v13, v156, v2, 0
  v_dot2c_f32_bf16 v10, v145, v3
  v_dot2c_f32_bf16 v11, v149, v3
  v_dot2c_f32_bf16 v12, v153, v3
  v_dot2c_f32_bf16 v13, v157, v3
  v_dot2c_f32_bf16 v10, v146, v4
  v_dot2c_f32_bf16 v11, v150, v4
  v_dot2c_f32_bf16 v12, v154, v4
  v_dot2c_f32_bf16 v13, v158, v4
  v_dot2c_f32_bf16 v10, v147, v5
  v_dot2c_f32_bf16 v11, v151, v5
  v_dot2c_f32_bf16 v12, v155, v5
  v_dot2c_f32_bf16 v13, v159, v5
  s_waitcnt vmcnt(4)
  buffer_load_dwordx4 v[144:147], v1, s[36:39], s40 offen offset:0 nt
  s_waitcnt vmcnt(4)
  buffer_load_dwordx4 v[148:151], v1, s[36:39], s40 offen offset:1024 nt
  s_waitcnt vmcnt(4)
  buffer_load_dwordx4 v[152:155], v1, s[36:39], s40 offen offset:2048 nt
  s_waitcnt vmcnt(4)
  buffer_load_dwordx4 v[156:159], v1, s[36:39], s40 offen offset:3072 nt
  s_add_u32 s40, s40, 16384
  s_and_b32 s40, s40, 0x7ffff
  v_permlane16_swap_b32 v10, v11
  v_permlane16_swap_b32 v12, v13
  v_add_f32 v10, v10, v11
  v_add_f32 v12, v12, v13
  s_nop 0
  v_add_f32_dpp v15, v10, v10 row_ror:8 row_mask:0xf bank_mask:0x3
  s_nop 1
  v_add_f32_dpp v15, v12, v12 row_ror:8 row_mask:0xf bank_mask:0xc
  v_add_f32_dpp v16, v14, v14 row_shl:4 row_mask:0xf bank_mask:0x5
  s_nop 1
  v_add_f32_dpp v16, v15, v15 row_shr:4 row_mask:0xf bank_mask:0xa
  s_waitcnt vmcnt(5)
  v_dot2_f32_bf16 v10, v160, v2, 0
  v_dot2_f32_bf16 v11, v164, v2, 0
  v_dot2_f32_bf16 v12, v168, v2, 0
  v_dot2_f32_bf16 v13, v172, v2, 0
  v_dot2c_f32_bf16 v10, v161, v3
  v_dot2c_f32_bf16 v11, v165, v3
  v_dot2c_f32_bf16 v12, v169, v3
  v_dot2c_f32_bf16 v13, v173, v3
  v_dot2c_f32_bf16 v10, v162, v4
  v_dot2c_f32_bf16 v11, v166, v4
  v_dot2c_f32_bf16 v12, v170, v4
  v_dot2c_f32_bf16 v13, v174, v4
  v_dot2c_f32_bf16 v10, v163, v5
  v_dot2c_f32_bf16 v11, v167, v5
  v_dot2c_f32_bf16 v12, v171, v5
  v_dot2c_f32_bf16 v13, v175, v5
  s_waitcnt vmcnt(4)
  buffer_load_dwordx4 v[160:163], v1, s[36:39], s40 offen offset:0 nt
  s_waitcnt vmcnt(4)
  buffer_load_dwordx4 v[164:167], v1, s[36:39], s40 offen offset:1024 nt
  s_waitcnt vmcnt(4)
  buffer_load_dwordx4 v[168:171], v1, s[36:39], s40 offen offset:2048 nt
  s_waitcnt vmcnt(4)
  buffer_load_dwordx4 v[172:175], v1, s[36:39], s40 offen offset:3072 nt
  s_add_u32 s40, s40, 16384
  s_and_b32 s40, s40, 0x7ffff
  v_permlane16_swap_b32 v10, v11
  v_permlane16_swap_b32 v12, v13
  v_add_f32 v10, v10, v11
  v_add_f32 v12, v12, v13
  s_nop 0
  v_add_f32_dpp v14, v10, v10 row_ror:8 row_mask:0xf bank_mask:0x3
  s_nop 1
  v_add_f32_dpp v14, v12, v12 row_ror:8 row_mask:0xf bank_mask:0xc
  s_waitcnt vmcnt(5)
  v_dot2_f32_bf16 v10, v176, v2, 0
  v_dot2_f32_bf16 v11, v180, v2, 0
  v_dot2_f32_bf16 v12, v184, v2, 0
  v_dot2_f32_bf16 v13, v188, v2, 0
  v_dot2c_f32_bf16 v10, v177, v3
  v_dot2c_f32_bf16 v11, v181, v3
  v_dot2c_f32_bf16 v12, v185, v3
  v_dot2c_f32_bf16 v13, v189, v3
  v_dot2c_f32_bf16 v10, v178, v4
  v_dot2c_f32_bf16 v11, v182, v4
  v_dot2c_f32_bf16 v12, v186, v4
  v_dot2c_f32_bf16 v13, v190, v4
  v_dot2c_f32_bf16 v10, v179, v5
  v_dot2c_f32_bf16 v11, v183, v5
  v_dot2c_f32_bf16 v12, v187, v5
  v_dot2c_f32_bf16 v13, v191, v5
  s_waitcnt vmcnt(4)
  buffer_load_dwordx4 v[176:179], v1, s[36:39], s40 offen offset:0 nt
  s_waitcnt vmcnt(4)
  buffer_load_dwordx4 v[180:183], v1, s[36:39], s40 offen offset:1024 nt
  s_waitcnt vmcnt(4)
  buffer_load_dwordx4 v[184:187], v1, s[36:39], s40 offen offset:2048 nt
  s_waitcnt vmcnt(4)
  buffer_load_dwordx4 v[188:191], v1, s[36:39], s40 offen offset:3072 nt
  s_add_u32 s40, s40, 16384
  s_and_b32 s40, s40, 0x7ffff
  v_permlane16_swap_b32 v10, v11
  v_permlane16_swap_b32 v12, v13
  v_add_f32 v10, v10, v11
  v_add_f32 v12, v12, v13
  s_nop 0
  v_add_f32_dpp v15, v10, v10 row_ror:8 row_mask:0xf bank_mask:0x3
  s_nop 1
  v_add_f32_dpp v15, v12, v12 row_ror:8 row_mask:0xf bank_mask:0xc
  v_add_f32_dpp v17, v14, v14 row_shl:4 row_mask:0xf bank_mask:0x5
  s_nop 1
  v_add_f32_dpp v17, v15, v15 row_shr:4 row_mask:0xf bank_mask:0xa
  v_add_f32_dpp v20, v16, v16 quad_perm:[2,3,0,1] row_mask:0xf bank_mask:0xf
  s_nop 0
  v_add_f32_dpp v21, v17, v17 quad_perm:[2,3,0,1] row_mask:0xf bank_mask:0xf
  v_cndmask_b32 v18, v20, v21, s[42:43]
  s_waitcnt vmcnt(5)
  v_dot2_f32_bf16 v10, v192, v2, 0
  v_dot2_f32_bf16 v11, v196, v2, 0
  v_dot2_f32_bf16 v12, v200, v2, 0
  v_dot2_f32_bf16 v13, v204, v2, 0
  v_dot2c_f32_bf16 v10, v193, v3
  v_dot2c_f32_bf16 v11, v197, v3
  v_dot2c_f32_bf16 v12, v201, v3
  v_dot2c_f32_bf16 v13, v205, v3
  v_dot2c_f32_bf16 v10, v194, v4
  v_dot2c_f32_bf16 v11, v198, v4
  v_dot2c_f32_bf16 v12, v202, v4
  v_dot2c_f32_bf16 v13, v206, v4
  v_dot2c_f32_bf16 v10, v195, v5
  v_dot2c_f32_bf16 v11, v199, v5
  v_dot2c_f32_bf16 v12, v203, v5
  v_dot2c_f32_bf16 v13, v207, v5
  s_waitcnt vmcnt(4)
  buffer_load_dwordx4 v[192:195], v1, s[36:39], s40 offen offset:0 nt
  s_waitcnt vmcnt(4)
  buffer_load_dwordx4 v[196:199], v1, s[36:39], s40 offen offset:1024 nt
  s_waitcnt vmcnt(4)
  buffer_load_dwordx4 v[200:203], v1, s[36:39], s40 offen offset:2048 nt
  s_waitcnt vmcnt(4)
  buffer_load_dwordx4 v[204:207], v1, s[36:39], s40 offen offset:3072 nt
  s_add_u32 s40, s40, 16384
  s_and_b32 s40, s40, 0x7ffff
  v_permlane16_swap_b32 v10, v11
  v_permlane16_swap_b32 v12, v13
  v_add_f32 v10, v10, v11
  v_add_f32 v12, v12, v13
  s_nop 0
  v_add_f32_dpp v14, v10, v10 row_ror:8 row_mask:0xf bank_mask:0x3
  s_nop 1
  v_add_f32_dpp v14, v12, v12 row_ror:8 row_mask:0xf bank_mask:0xc
  s_waitcnt vmcnt(5)
  v_dot2_f32_bf16 v10, v208, v2, 0
  v_dot2_f32_bf16 v11, v212, v2, 0
  v_dot2_f32_bf16 v12, v216, v2, 0
  v_dot2_f32_bf16 v13, v220, v2, 0
  v_dot2c_f32_bf16 v10, v209, v3
  v_dot2c_f32_bf16 v11, v213, v3
  v_dot2c_f32_bf16 v12, v217, v3
  v_dot2c_f32_bf16 v13, v221, v3
  v_dot2c_f32_bf16 v10, v210, v4
  v_dot2c_f32_bf16 v11, v214, v4
  v_dot2c_f32_bf16 v12, v218, v4
  v_dot2c_f32_bf16 v13, v222, v4
  v_dot2c_f32_bf16 v10, v211, v5
  v_dot2c_f32_bf16 v11, v215, v5
  v_dot2c_f32_bf16 v12, v219, v5
  v_dot2c_f32_bf16 v13, v223, v5
  s_waitcnt vmcnt(4)
  buffer_load_dwordx4 v[208:211], v1, s[36:39], s40 offen offset:0 nt
  s_waitcnt vmcnt(4)
  buffer_load_dwordx4 v[212:215], v1, s[36:39], s40 offen offset:1024 nt
  s_waitcnt vmcnt(4)
  buffer_load_dwordx4 v[216:219], v1, s[36:39], s40 offen offset:2048 nt
  s_waitcnt vmcnt(4)
  buffer_load_dwordx4 v[220:223], v1, s[36:39], s40 offen offset:3072 nt
  s_add_u32 s40, s40, 16384
  s_and_b32 s40, s40, 0x7ffff
  v_permlane16_swap_b32 v10, v11
  v_permlane16_swap_b32 v12, v13
  v_add_f32 v10, v10, v11
  v_add_f32 v12, v12, v13
  s_nop 0
  v_add_f32_dpp v15, v10, v10 row_ror:8 row_mask:0xf bank_mask:0x3
  s_nop 1
  v_add_f32_dpp v15, v12, v12 row_ror:8 row_mask:0xf bank_mask:0xc
  v_add_f32_dpp v16, v14, v14 row_shl:4 row_mask:0xf bank_mask:0x5
  s_nop 1
  v_add_f32_dpp v16, v15, v15 row_shr:4 row_mask:0xf bank_mask:0xa
  s_waitcnt vmcnt(5)
  v_dot2_f32_bf16 v10, v224, v2, 0
  v_dot2_f32_bf16 v11, v228, v2, 0
  v_dot2_f32_bf16 v12, v232, v2, 0
  v_dot2_f32_bf16 v13, v236, v2, 0
  v_dot2c_f32_bf16 v10, v225, v3
  v_dot2c_f32_bf16 v11, v229, v3
  v_dot2c_f32_bf16 v12, v233, v3
  v_dot2c_f32_bf16 v13, v237, v3
  v_dot2c_f32_bf16 v10, v226, v4
  v_dot2c_f32_bf16 v11, v230, v4
  v_dot2c_f32_bf16 v12, v234, v4
  v_dot2c_f32_bf16 v13, v238, v4
  v_dot2c_f32_bf16 v10, v227, v5
  v_dot2c_f32_bf16 v11, v231, v5
  v_dot2c_f32_bf16 v12, v235, v5
  v_dot2c_f32_bf16 v13, v239, v5
  s_waitcnt vmcnt(4)
  buffer_load_dwordx4 v[224:227], v1, s[36:39], s40 offen offset:0 nt
  s_waitcnt vmcnt(4)
  buffer_load_dwordx4 v[228:231], v1, s[36:39], s40 offen offset:1024 nt
  s_waitcnt vmcnt(4)
  buffer_load_dwordx4 v[232:235], v1, s[36:39], s40 offen offset:2048 nt
  s_waitcnt vmcnt(4)
  buffer_load_dwordx4 v[236:239], v1, s[36:39], s40 offen offset:3072 nt
  s_add_u32 s40, s40, 16384
  s_and_b32 s40, s40, 0x7ffff
  v_permlane16_swap_b32 v10, v11
  v_permlane16_swap_b32 v12, v13
  v_add_f32 v10, v10, v11
  v_add_f32 v12, v12, v13
  s_nop 0
  v_add_f32_dpp v14, v10, v10 row_ror:8 row_mask:0xf bank_mask:0x3
  s_nop 1
  v_add_f32_dpp v14, v12, v12 row_ror:8 row_mask:0xf bank_mask:0xc
  s_waitcnt vmcnt(5)
  v_dot2_f32_bf16 v10, v240, v2, 0
  v_dot2_f32_bf16 v11, v244, v2, 0
  v_dot2_f32_bf16 v12, v248, v2, 0
  v_dot2_f32_bf16 v13, v252, v2, 0
  v_dot2c_f32_bf16 v10, v241, v3
  v_dot2c_f32_bf16 v11, v245, v3
  v_dot2c_f32_bf16 v12, v249, v3
  v_dot2c_f32_bf16 v13, v253, v3
  v_dot2c_f32_bf16 v10, v242, v4
  v_dot2c_f32_bf16 v11, v246, v4
  v_dot2c_f32_bf16 v12, v250, v4
  v_dot2c_f32_bf16 v13, v254, v4
  v_dot2c_f32_bf16 v10, v243, v5
  v_dot2c_f32_bf16 v11, v247, v5
  v_dot2c_f32_bf16 v12, v251, v5
  v_dot2c_f32_bf16 v13, v255, v5
  s_waitcnt vmcnt(4)
  buffer_load_dwordx4 v[240:243], v1, s[36:39], s40 offen offset:0 nt
  s_waitcnt vmcnt(4)
  buffer_load_dwordx4 v[244:247], v1, s[36:39], s40 offen offset:1024 nt
  s_waitcnt vmcnt(4)
  buffer_load_dwordx4 v[248:251], v1, s[36:39], s40 offen offset:2048 nt
  s_waitcnt vmcnt(4)
  buffer_load_dwordx4 v[252:255], v1, s[36:39], s40 offen offset:3072 nt
  s_add_u32 s40, s40, 16384
  s_and_b32 s40, s40, 0x7ffff
  v_permlane16_swap_b32 v10, v11
  v_permlane16_swap_b32 v12, v13
  v_add_f32 v10, v10, v11
  v_add_f32 v12, v12, v13
  s_nop 0
  v_add_f32_dpp v15, v10, v10 row_ror:8 row_mask:0xf bank_mask:0x3
  s_nop 1
  v_add_f32_dpp v15, v12, v12 row_ror:8 row_mask:0xf bank_mask:0xc
  v_add_f32_dpp v17, v14, v14 row_shl:4 row_mask:0xf bank_mask:0x5
  s_nop 1
  v_add_f32_dpp v17, v15, v15 row_shr:4 row_mask:0xf bank_mask:0xa
  v_add_f32_dpp v20, v16, v16 quad_perm:[2,3,0,1] row_mask:0xf bank_mask:0xf
  s_nop 0
  v_add_f32_dpp v21, v17, v17 quad_perm:[2,3,0,1] row_mask:0xf bank_mask:0xf
  v_cndmask_b32 v19, v20, v21, s[42:43]
  v_add_f32_dpp v20, v18, v18 quad_perm:[1,0,3,2] row_mask:0xf bank_mask:0xf
  s_nop 0
  v_add_f32_dpp v21, v19, v19 quad_perm:[1,0,3,2] row_mask:0xf bank_mask:0xf
  v_mov_b32 v6, v7
  v_mov_b32 v7, v8
  v_mov_b32 v8, v9
  v_cndmask_b32 v9, v20, v21, s[44:45]
  s_add_u32 s41, s41, 1
  s_cmp_lt_u32 s41, 3
  s_cbranch_scc1 L_kloop
  s_mov_b32 s36, s8
  s_mov_b32 s37, s9
  s_waitcnt vmcnt(5)
  v_dot2_f32_bf16 v10, v128, v2, 0
  v_dot2_f32_bf16 v11, v132, v2, 0
  v_dot2_f32_bf16 v12, v136, v2, 0
  v_dot2_f32_bf16 v13, v140, v2, 0
  v_dot2c_f32_bf16 v10, v129, v3
  v_dot2c_f32_bf16 v11, v133, v3
  v_dot2c_f32_bf16 v12, v137, v3
  v_dot2c_f32_bf16 v13, v141, v3
  v_dot2c_f32_bf16 v10, v130, v4
  v_dot2c_f32_bf16 v11, v134, v4
  v_dot2c_f32_bf16 v12, v138, v4
  v_dot2c_f32_bf16 v13, v142, v4
  v_dot2c_f32_bf16 v10, v131, v5
  v_dot2c_f32_bf16 v11, v135, v5
  v_dot2c_f32_bf16 v12, v139, v5
  v_dot2c_f32_bf16 v13, v143, v5
  s_waitcnt vmcnt(4)
  buffer_load_dwordx4 v[128:131], v1, s[36:39], s40 offen offset:0 nt
  s_waitcnt vmcnt(4)
  buffer_load_dwordx4 v[132:135], v1, s[36:39], s40 offen offset:1024 nt
  s_waitcnt vmcnt(4)
  buffer_load_dwordx4 v[136:139], v1, s[36:39], s40 offen offset:2048 nt
  s_waitcnt vmcnt(4)
  buffer_load_dwordx4 v[140:143], v1, s[36:39], s40 offen offset:3072 nt
  s_add_u32 s40, s40, 16384
  s_and_b32 s40, s40, 0x7ffff
  v_permlane16_swap_b32 v10, v11
  v_permlane16_swap_b32 v12, v13
  v_add_f32 v10, v10, v11
  v_add_f32 v12, v12, v13
  s_nop 0
  v_add_f32_dpp v14, v10, v10 row_ror:8 row_mask:0xf bank_mask:0x3
  s_nop 1
  v_add_f32_dpp v14, v12, v12 row_ror:8 row_mask:0xf bank_mask:0xc
  s_waitcnt vmcnt(5)
  v_dot2_f32_bf16 v10, v144, v2, 0
  v_dot2_f32_bf16 v11, v148, v2, 0
  v_dot2_f32_bf16 v12, v152, v2, 0
  v_dot2_f32_bf16 v13, v156, v2, 0
  v_dot2c_f32_bf16 v10, v145, v3
  v_dot2c_f32_bf16 v11, v149, v3
  v_dot2c_f32_bf16 v12, v153, v3
  v_dot2c_f32_bf16 v13, v157, v3
  v_dot2c_f32_bf16 v10, v146, v4
  v_dot2c_f32_bf16 v11, v150, v4
  v_dot2c_f32_bf16 v12, v154, v4
  v_dot2c_f32_bf16 v13, v158, v4
  v_dot2c_f32_bf16 v10, v147, v5
  v_dot2c_f32_bf16 v11, v151, v5
  v_dot2c_f32_bf16 v12, v155, v5
  v_dot2c_f32_bf16 v13, v159, v5
  s_waitcnt vmcnt(4)
  buffer_load_dwordx4 v[144:147], v1, s[36:39], s40 offen offset:0 nt
  s_waitcnt vmcnt(4)
  buffer_load_dwordx4 v[148:151], v1, s[36:39], s40 offen offset:1024 nt
  s_waitcnt vmcnt(4)
  buffer_load_dwordx4 v[152:155], v1, s[36:39], s40 offen offset:2048 nt
  s_waitcnt vmcnt(4)
  buffer_load_dwordx4 v[156:159], v1, s[36:39], s40 offen offset:3072 nt
  s_add_u32 s40, s40, 16384
  s_and_b32 s40, s40, 0x7ffff
  v_permlane16_swap_b32 v10, v11
  v_permlane16_swap_b32 v12, v13
  v_add_f32 v10, v10, v11
  v_add_f32 v12, v12, v13
  s_nop 0
  v_add_f32_dpp v15, v10, v10 row_ror:8 row_mask:0xf bank_mask:0x3
  s_nop 1
  v_add_f32_dpp v15, v12, v12 row_ror:8 row_mask:0xf bank_mask:0xc
  v_add_f32_dpp v16, v14, v14 row_shl:4 row_mask:0xf bank_mask:0x5
  s_nop 1
  v_add_f32_dpp v16, v15, v15 row_shr:4 row_mask:0xf bank_mask:0xa
  s_waitcnt vmcnt(5)
  v_dot2_f32_bf16 v10, v160, v2, 0
  v_dot2_f32_bf16 v11, v164, v2, 0
  v_dot2_f32_bf16 v12, v168, v2, 0
  v_dot2_f32_bf16 v13, v172, v2, 0
  v_dot2c_f32_bf16 v10, v161, v3
  v_dot2c_f32_bf16 v11, v165, v3
  v_dot2c_f32_bf16 v12, v169, v3
  v_dot2c_f32_bf16 v13, v173, v3
  v_dot2c_f32_bf16 v10, v162, v4
  v_dot2c_f32_bf16 v11, v166, v4
  v_dot2c_f32_bf16 v12, v170, v4
  v_dot2c_f32_bf16 v13, v174, v4
  v_dot2c_f32_bf16 v10, v163, v5
  v_dot2c_f32_bf16 v11, v167, v5
  v_dot2c_f32_bf16 v12, v171, v5
  v_dot2c_f32_bf16 v13, v175, v5
  s_waitcnt vmcnt(4)
  buffer_load_dwordx4 v[160:163], v1, s[36:39], s40 offen offset:0 nt
  s_waitcnt vmcnt(4)
  buffer_load_dwordx4 v[164:167], v1, s[36:39], s40 offen offset:1024 nt
  s_waitcnt vmcnt(4)
  buffer_load_dwordx4 v[168:171], v1, s[36:39], s40 offen offset:2048 nt
  s_waitcnt vmcnt(4)
  buffer_load_dwordx4 v[172:175], v1, s[36:39], s40 offen offset:3072 nt
  s_add_u32 s40, s40, 16384
  s_and_b32 s40, s40, 0x7ffff
  v_permlane16_swap_b32 v10, v11
  v_permlane16_swap_b32 v12, v13
  v_add_f32 v10, v10, v11
  v_add_f32 v12, v12, v13
  s_nop 0
  v_add_f32_dpp v14, v10, v10 row_ror:8 row_mask:0xf bank_mask:0x3
  s_nop 1
  v_add_f32_dpp v14, v12, v12 row_ror:8 row_mask:0xf bank_mask:0xc
  s_waitcnt vmcnt(5)
  v_dot2_f32_bf16 v10, v176, v2, 0
  v_dot2_f32_bf16 v11, v180, v2, 0
  v_dot2_f32_bf16 v12, v184, v2, 0
  v_dot2_f32_bf16 v13, v188, v2, 0
  v_dot2c_f32_bf16 v10, v177, v3
  v_dot2c_f32_bf16 v11, v181, v3
  v_dot2c_f32_bf16 v12, v185, v3
  v_dot2c_f32_bf16 v13, v189, v3
  v_dot2c_f32_bf16 v10, v178, v4
  v_dot2c_f32_bf16 v11, v182, v4
  v_dot2c_f32_bf16 v12, v186, v4
  v_dot2c_f32_bf16 v13, v190, v4
  v_dot2c_f32_bf16 v10, v179, v5
  v_dot2c_f32_bf16 v11, v183, v5
  v_dot2c_f32_bf16 v12, v187, v5
  v_dot2c_f32_bf16 v13, v191, v5
  s_waitcnt vmcnt(4)
  buffer_load_dwordx4 v[176:179], v1, s[36:39], s40 offen offset:0 nt
  s_waitcnt vmcnt(4)
  buffer_load_dwordx4 v[180:183], v1, s[36:39], s40 offen offset:1024 nt
  s_waitcnt vmcnt(4)
  buffer_load_dwordx4 v[184:187], v1, s[36:39], s40 offen offset:2048 nt
  s_waitcnt vmcnt(4)
  buffer_load_dwordx4 v[188:191], v1, s[36:39], s40 offen offset:3072 nt
  s_add_u32 s40, s40, 16384
  s_and_b32 s40, s40, 0x7ffff
  v_permlane16_swap_b32 v10, v11
  v_permlane16_swap_b32 v12, v13
  v_add_f32 v10, v10, v11
  v_add_f32 v12, v12, v13
  s_nop 0
  v_add_f32_dpp v15, v10, v10 row_ror:8 row_mask:0xf bank_mask:0x3
  s_nop 1
  v_add_f32_dpp v15, v12, v12 row_ror:8 row_mask:0xf bank_mask:0xc
  v_add_f32_dpp v17, v14, v14 row_shl:4 row_mask:0xf bank_mask:0x5
  s_nop 1
  v_add_f32_dpp v17, v15, v15 row_shr:4 row_mask:0xf bank_mask:0xa
  v_add_f32_dpp v20, v16, v16 quad_perm:[2,3,0,1] row_mask:0xf bank_mask:0xf
  s_nop 0
  v_add_f32_dpp v21, v17, v17 quad_perm:[2,3,0,1] row_mask:0xf bank_mask:0xf
  v_cndmask_b32 v18, v20, v21, s[42:43]
  s_waitcnt vmcnt(5)
  v_dot2_f32_bf16 v10, v192, v2, 0
  v_dot2_f32_bf16 v11, v196, v2, 0
  v_dot2_f32_bf16 v12, v200, v2, 0
  v_dot2_f32_bf16 v13, v204, v2, 0
  v_dot2c_f32_bf16 v10, v193, v3
  v_dot2c_f32_bf16 v11, v197, v3
  v_dot2c_f32_bf16 v12, v201, v3
  v_dot2c_f32_bf16 v13, v205, v3
  v_dot2c_f32_bf16 v10, v194, v4
  v_dot2c_f32_bf16 v11, v198, v4
  v_dot2c_f32_bf16 v12, v202, v4
  v_dot2c_f32_bf16 v13, v206, v4
  v_dot2c_f32_bf16 v10, v195, v5
  v_dot2c_f32_bf16 v11, v199, v5
  v_dot2c_f32_bf16 v12, v203, v5
  v_dot2c_f32_bf16 v13, v207, v5
  s_waitcnt vmcnt(4)
  buffer_load_dwordx4 v[192:195], v1, s[36:39], s40 offen offset:0 nt
  s_waitcnt vmcnt(4)
  buffer_load_dwordx4 v[196:199], v1, s[36:39], s40 offen offset:1024 nt
  s_waitcnt vmcnt(4)
  buffer_load_dwordx4 v[200:203], v1, s[36:39], s40 offen offset:2048 nt
  s_waitcnt vmcnt(4)
  buffer_load_dwordx4 v[204:207], v1, s[36:39], s40 offen offset:3072 nt
  s_add_u32 s40, s40, 16384
  s_and_b32 s40, s40, 0x7ffff
  v_permlane16_swap_b32 v10, v11
  v_permlane16_swap_b32 v12, v13
  v_add_f32 v10, v10, v11
  v_add_f32 v12, v12, v13
  s_nop 0
  v_add_f32_dpp v14, v10, v10 row_ror:8 row_mask:0xf bank_mask:0x3
  s_nop 1
  v_add_f32_dpp v14, v12, v12 row_ror:8 row_mask:0xf bank_mask:0xc
  s_waitcnt vmcnt(5)
  v_dot2_f32_bf16 v10, v208, v2, 0
  v_dot2_f32_bf16 v11, v212, v2, 0
  v_dot2_f32_bf16 v12, v216, v2, 0
  v_dot2_f32_bf16 v13, v220, v2, 0
  v_dot2c_f32_bf16 v10, v209, v3
  v_dot2c_f32_bf16 v11, v213, v3
  v_dot2c_f32_bf16 v12, v217, v3
  v_dot2c_f32_bf16 v13, v221, v3
  v_dot2c_f32_bf16 v10, v210, v4
  v_dot2c_f32_bf16 v11, v214, v4
  v_dot2c_f32_bf16 v12, v218, v4
  v_dot2c_f32_bf16 v13, v222, v4
  v_dot2c_f32_bf16 v10, v211, v5
  v_dot2c_f32_bf16 v11, v215, v5
  v_dot2c_f32_bf16 v12, v219, v5
  v_dot2c_f32_bf16 v13, v223, v5
  s_waitcnt vmcnt(4)
  buffer_load_dwordx4 v[208:211], v1, s[36:39], s40 offen offset:0 nt
  s_waitcnt vmcnt(4)
  buffer_load_dwordx4 v[212:215], v1, s[36:39], s40 offen offset:1024 nt
  s_waitcnt vmcnt(4)
  buffer_load_dwordx4 v[216:219], v1, s[36:39], s40 offen offset:2048 nt
  s_waitcnt vmcnt(4)
  buffer_load_dwordx4 v[220:223], v1, s[36:39], s40 offen offset:3072 nt
  s_add_u32 s40, s40, 16384
  s_and_b32 s40, s40, 0x7ffff
  v_permlane16_swap_b32 v10, v11
  v_permlane16_swap_b32 v12, v13
  v_add_f32 v10, v10, v11
  v_add_f32 v12, v12, v13
  s_nop 0
  v_add_f32_dpp v15, v10, v10 row_ror:8 row_mask:0xf bank_mask:0x3
  s_nop 1
  v_add_f32_dpp v15, v12, v12 row_ror:8 row_mask:0xf bank_mask:0xc
  v_add_f32_dpp v16, v14, v14 row_shl:4 row_mask:0xf bank_mask:0x5
  s_nop 1
  v_add_f32_dpp v16, v15, v15 row_shr:4 row_mask:0xf bank_mask:0xa
  s_waitcnt vmcnt(5)
  v_dot2_f32_bf16 v10, v224, v2, 0
  v_dot2_f32_bf16 v11, v228, v2, 0
  v_dot2_f32_bf16 v12, v232, v2, 0
  v_dot2_f32_bf16 v13, v236, v2, 0
  v_dot2c_f32_bf16 v10, v225, v3
  v_dot2c_f32_bf16 v11, v229, v3
  v_dot2c_f32_bf16 v12, v233, v3
  v_dot2c_f32_bf16 v13, v237, v3
  v_dot2c_f32_bf16 v10, v226, v4
  v_dot2c_f32_bf16 v11, v230, v4
  v_dot2c_f32_bf16 v12, v234, v4
  v_dot2c_f32_bf16 v13, v238, v4
  v_dot2c_f32_bf16 v10, v227, v5
  v_dot2c_f32_bf16 v11, v231, v5
  v_dot2c_f32_bf16 v12, v235, v5
  v_dot2c_f32_bf16 v13, v239, v5
  s_waitcnt vmcnt(4)
  buffer_load_dwordx4 v[224:227], v1, s[36:39], s40 offen offset:0 nt
  s_waitcnt vmcnt(4)
  buffer_load_dwordx4 v[228:231], v1, s[36:39], s40 offen offset:1024 nt
  s_waitcnt vmcnt(4)
  buffer_load_dwordx4 v[232:235], v1, s[36:39], s40 offen offset:2048 nt
  s_waitcnt vmcnt(4)
  buffer_load_dwordx4 v[236:239], v1, s[36:39], s40 offen offset:3072 nt
  s_add_u32 s40, s40, 16384
  s_and_b32 s40, s40, 0x7ffff
  v_permlane16_swap_b32 v10, v11
  v_permlane16_swap_b32 v12, v13
  v_add_f32 v10, v10, v11
  v_add_f32 v12, v12, v13
  s_nop 0
  v_add_f32_dpp v14, v10, v10 row_ror:8 row_mask:0xf bank_mask:0x3
  s_nop 1
  v_add_f32_dpp v14, v12, v12 row_ror:8 row_mask:0xf bank_mask:0xc
  s_waitcnt vmcnt(5)
  v_dot2_f32_bf16 v10, v240, v2, 0
  v_dot2_f32_bf16 v11, v244, v2, 0
  v_dot2_f32_bf16 v12, v248, v2, 0
  v_dot2_f32_bf16 v13, v252, v2, 0
  v_dot2c_f32_bf16 v10, v241, v3
  v_dot2c_f32_bf16 v11, v245, v3
  v_dot2c_f32_bf16 v12, v249, v3
  v_dot2c_f32_bf16 v13, v253, v3
  v_dot2c_f32_bf16 v10, v242, v4
  v_dot2c_f32_bf16 v11, v246, v4
  v_dot2c_f32_bf16 v12, v250, v4
  v_dot2c_f32_bf16 v13, v254, v4
  v_dot2c_f32_bf16 v10, v243, v5
  v_dot2c_f32_bf16 v11, v247, v5
  v_dot2c_f32_bf16 v12, v251, v5
  v_dot2c_f32_bf16 v13, v255, v5
  s_waitcnt vmcnt(4)
  buffer_load_dwordx4 v[240:243], v1, s[36:39], s40 offen offset:0 nt
  s_waitcnt vmcnt(4)
  buffer_load_dwordx4 v[244:247], v1, s[36:39], s40 offen offset:1024 nt
  s_waitcnt vmcnt(4)
  buffer_load_dwordx4 v[248:251], v1, s[36:39], s40 offen offset:2048 nt
  s_waitcnt vmcnt(4)
  buffer_load_dwordx4 v[252:255], v1, s[36:39], s40 offen offset:3072 nt
  s_add_u32 s40, s40, 16384
  s_and_b32 s40, s40, 0x7ffff
  v_permlane16_swap_b32 v10, v11
  v_permlane16_swap_b32 v12, v13
  v_add_f32 v10, v10, v11
  v_add_f32 v12, v12, v13
  s_nop 0
  v_add_f32_dpp v15, v10, v10 row_ror:8 row_mask:0xf bank_mask:0x3
  s_nop 1
  v_add_f32_dpp v15, v12, v12 row_ror:8 row_mask:0xf bank_mask:0xc
  v_add_f32_dpp v17, v14, v14 row_shl:4 row_mask:0xf bank_mask:0x5
  s_nop 1
  v_add_f32_dpp v17, v15, v15 row_shr:4 row_mask:0xf bank_mask:0xa
  v_add_f32_dpp v20, v16, v16 quad_perm:[2,3,0,1] row_mask:0xf bank_mask:0xf
  s_nop 0
  v_add_f32_dpp v21, v17, v17 quad_perm:[2,3,0,1] row_mask:0xf bank_mask:0xf
  v_cndmask_b32 v19, v20, v21, s[42:43]
  v_add_f32_dpp v20, v18, v18 quad_perm:[1,0,3,2] row_mask:0xf bank_mask:0xf
  s_nop 0
  v_add_f32_dpp v21, v19, v19 quad_perm:[1,0,3,2] row_mask:0xf bank_mask:0xf
  v_mov_b32 v6, v7
  v_mov_b32 v7, v8
  v_mov_b32 v8, v9
  v_cndmask_b32 v9, v20, v21, s[44:45]
  s_waitcnt vmcnt(9)
  buffer_load_dwordx4 v[76:79], v1, s[36:39], s40 offen offset:0 nt
  s_waitcnt vmcnt(9)
  buffer_load_dwordx4 v[80:83], v1, s[36:39], s40 offen offset:1024 nt
  s_waitcnt vmcnt(9)
  buffer_load_dwordx4 v[84:87], v1, s[36:39], s40 offen offset:2048 nt
  s_waitcnt vmcnt(9)
  buffer_load_dwordx4 v[88:91], v1, s[36:39], s40 offen offset:3072 nt
  s_add_u32 s40, s40, 16384
  s_and_b32 s40, s40, 0x7ffff
  v_cvt_pk_bf16_f32 v10, v6, v7
  v_cvt_pk_bf16_f32 v11, v8, v9
  s_mov_b32 s47, 1035512379
  v_lshlrev_b32 v6, 16, v10
  v_and_b32 v7, 0xffff0000, v10
  v_lshlrev_b32 v8, 16, v11
  v_and_b32 v9, 0xffff0000, v11
  v_max3_f32 v12, v6, v7, v8
  v_max_f32 v12, v12, v9
  s_nop 1
  v_max_f32_dpp v12, v12, v12 row_ror:8 row_mask:0xf bank_mask:0xf
  s_nop 1
  v_max_f32_dpp v12, v12, v12 row_ror:4 row_mask:0xf bank_mask:0xf
  s_nop 1
  v_max_f32_dpp v12, v12, v12 row_ror:2 row_mask:0xf bank_mask:0xf
  s_nop 1
  v_max_f32_dpp v12, v12, v12 row_ror:1 row_mask:0xf bank_mask:0xf
  v_mov_b32 v13, v12
  s_nop 1
  v_permlane16_swap_b32 v12, v13
  v_max_f32 v12, v12, v13
  v_mov_b32 v13, v12
  s_nop 1
  v_permlane32_swap_b32 v12, v13
  v_max_f32 v12, v12, v13
  v_sub_f32 v6, v6, v12
  v_mul_f32 v6, s47, v6
  v_exp_f32 v6, v6
  v_sub_f32 v7, v7, v12
  v_mul_f32 v7, s47, v7
  v_exp_f32 v7, v7
  v_sub_f32 v8, v8, v12
  v_mul_f32 v8, s47, v8
  v_exp_f32 v8, v8
  v_sub_f32 v9, v9, v12
  v_mul_f32 v9, s47, v9
  v_exp_f32 v9, v9
  v_add_f32 v13, v6, v7
  v_add_f32 v14, v8, v9
  v_add_f32 v13, v13, v14
  v_mov_b32 v15, v6
  s_nop 1
  v_permlane16_swap_b32 v6, v15
  v_cvt_pk_bf16_f32 v68, v6, v15
  v_mov_b32 v15, v7
  s_nop 1
  v_permlane16_swap_b32 v7, v15
  v_cvt_pk_bf16_f32 v69, v7, v15
  v_mov_b32 v15, v8
  s_nop 1
  v_permlane16_swap_b32 v8, v15
  v_cvt_pk_bf16_f32 v70, v8, v15
  v_mov_b32 v15, v9
  s_nop 1
  v_permlane16_swap_b32 v9, v15
  v_cvt_pk_bf16_f32 v71, v9, v15
  v_add_f32_dpp v13, v13, v13 row_ror:8 row_mask:0xf bank_mask:0xf
  s_nop 1
  v_add_f32_dpp v13, v13, v13 row_ror:4 row_mask:0xf bank_mask:0xf
  s_nop 1
  v_add_f32_dpp v13, v13, v13 row_ror:2 row_mask:0xf bank_mask:0xf
  s_nop 1
  v_add_f32_dpp v13, v13, v13 row_ror:1 row_mask:0xf bank_mask:0xf
  v_mov_b32 v14, v13
  s_nop 1
  v_permlane16_swap_b32 v13, v14
  v_add_f32 v13, v13, v14
  v_mov_b32 v14, v13
  s_nop 1
  v_permlane32_swap_b32 v13, v14
  v_add_f32 v13, v13, v14
  s_lshl_b32 s48, s46, 3
  v_mov_b32 v14, s48
  v_mov_b32 v15, 1
  s_mov_b64 exec, 1
  ds_write_b64 v14, v[12:13] offset:2560
  s_waitcnt lgkmcnt(0)
  ds_add_u32 v31, v15 offset:2704
  s_mov_b64 exec, -1
  v_mov_b32 v64, 0
  v_mov_b32 v65, 0
  v_mov_b32 v66, 0
  v_mov_b32 v67, 0
  ds_bpermute_b32 v32, v72, v68 offset:0
  ds_bpermute_b32 v33, v72, v68 offset:32
  ds_bpermute_b32 v34, v72, v68 offset:16
  ds_bpermute_b32 v35, v72, v68 offset:48
  ds_bpermute_b32 v36, v72, v68 offset:8
  ds_bpermute_b32 v37, v72, v68 offset:40
  ds_bpermute_b32 v38, v72, v68 offset:24
  ds_bpermute_b32 v39, v72, v68 offset:56
  s_waitcnt lgkmcnt(0)
  s_waitcnt vmcnt(32)
  v_perm_b32 v56, v32, v32, v48
  v_perm_b32 v57, v32, v32, v49
  v_perm_b32 v58, v32, v32, v50
  v_perm_b32 v59, v32, v32, v51
  v_perm_b32 v60, v32, v32, v52
  v_perm_b32 v61, v32, v32, v53
  v_perm_b32 v62, v32, v32, v54
  v_perm_b32 v63, v32, v32, v55
  v_mfma_f32_16x16x32_bf16 v[64:67], v[128:131], v[56:59], v[64:67]
  v_perm_b32 v56, v33, v33, v48
  v_perm_b32 v57, v33, v33, v49
  v_perm_b32 v58, v33, v33, v50
  v_perm_b32 v59, v33, v33, v51
  v_mfma_f32_16x16x32_bf16 v[64:67], v[132:135], v[60:63], v[64:67]
  v_perm_b32 v60, v33, v33, v52
  v_perm_b32 v61, v33, v33, v53
  v_perm_b32 v62, v33, v33, v54
  v_perm_b32 v63, v33, v33, v55
  v_mfma_f32_16x16x32_bf16 v[64:67], v[136:139], v[56:59], v[64:67]
  s_waitcnt vmcnt(4)
  buffer_load_dwordx4 v[128:131], v1, s[36:39], s40 offen offset:0 nt
  s_waitcnt vmcnt(4)
  buffer_load_dwordx4 v[132:135], v1, s[36:39], s40 offen offset:1024 nt
  v_mfma_f32_16x16x32_bf16 v[64:67], v[140:143], v[60:63], v[64:67]
  s_waitcnt vmcnt(4)
  buffer_load_dwordx4 v[136:139], v1, s[36:39], s40 offen offset:2048 nt
  s_waitcnt vmcnt(4)
  buffer_load_dwordx4 v[140:143], v1, s[36:39], s40 offen offset:3072 nt
  s_add_u32 s40, s40, 16384
  s_and_b32 s40, s40, 0x7ffff
  ds_bpermute_b32 v40, v72, v68 offset:4
  ds_bpermute_b32 v41, v72, v68 offset:36
  ds_bpermute_b32 v42, v72, v68 offset:20
  ds_bpermute_b32 v43, v72, v68 offset:52
  ds_bpermute_b32 v44, v72, v68 offset:12
  ds_bpermute_b32 v45, v72, v68 offset:44
  ds_bpermute_b32 v46, v72, v68 offset:28
  ds_bpermute_b32 v47, v72, v68 offset:60
  s_waitcnt vmcnt(32)
  v_perm_b32 v56, v34, v34, v48
  v_perm_b32 v57, v34, v34, v49
  v_perm_b32 v58, v34, v34, v50
  v_perm_b32 v59, v34, v34, v51
  v_perm_b32 v60, v34, v34, v52
  v_perm_b32 v61, v34, v34, v53
  v_perm_b32 v62, v34, v34, v54
  v_perm_b32 v63, v34, v34, v55
  v_mfma_f32_16x16x32_bf16 v[64:67], v[144:147], v[56:59], v[64:67]
  v_perm_b32 v56, v35, v35, v48
  v_perm_b32 v57, v35, v35, v49
  v_perm_b32 v58, v35, v35, v50
  v_perm_b32 v59, v35, v35, v51
  v_mfma_f32_16x16x32_bf16 v[64:67], v[148:151], v[60:63], v[64:67]
  v_perm_b32 v60, v35, v35, v52
  v_perm_b32 v61, v35, v35, v53
  v_perm_b32 v62, v35, v35, v54
  v_perm_b32 v63, v35, v35, v55
  v_mfma_f32_16x16x32_bf16 v[64:67], v[152:155], v[56:59], v[64:67]
  s_waitcnt vmcnt(4)
  buffer_load_dwordx4 v[144:147], v1, s[36:39], s40 offen offset:0 nt
  s_waitcnt vmcnt(4)
  buffer_load_dwordx4 v[148:151], v1, s[36:39], s40 offen offset:1024 nt
  v_mfma_f32_16x16x32_bf16 v[64:67], v[156:159], v[60:63], v[64:67]
  s_waitcnt vmcnt(4)
  buffer_load_dwordx4 v[152:155], v1, s[36:39], s40 offen offset:2048 nt
  s_waitcnt vmcnt(4)
  buffer_load_dwordx4 v[156:159], v1, s[36:39], s40 offen offset:3072 nt
  s_add_u32 s40, s40, 16384
  s_and_b32 s40, s40, 0x7ffff
  s_waitcnt vmcnt(32)
  v_perm_b32 v56, v36, v36, v48
  v_perm_b32 v57, v36, v36, v49
  v_perm_b32 v58, v36, v36, v50
  v_perm_b32 v59, v36, v36, v51
  v_perm_b32 v60, v36, v36, v52
  v_perm_b32 v61, v36, v36, v53
  v_perm_b32 v62, v36, v36, v54
  v_perm_b32 v63, v36, v36, v55
  v_mfma_f32_16x16x32_bf16 v[64:67], v[160:163], v[56:59], v[64:67]
  v_perm_b32 v56, v37, v37, v48
  v_perm_b32 v57, v37, v37, v49
  v_perm_b32 v58, v37, v37, v50
  v_perm_b32 v59, v37, v37, v51
  v_mfma_f32_16x16x32_bf16 v[64:67], v[164:167], v[60:63], v[64:67]
  v_perm_b32 v60, v37, v37, v52
  v_perm_b32 v61, v37, v37, v53
  v_perm_b32 v62, v37, v37, v54
  v_perm_b32 v63, v37, v37, v55
  v_mfma_f32_16x16x32_bf16 v[64:67], v[168:171], v[56:59], v[64:67]
  s_waitcnt vmcnt(4)
  buffer_load_dwordx4 v[160:163], v1, s[36:39], s40 offen offset:0 nt
  s_waitcnt vmcnt(4)
  buffer_load_dwordx4 v[164:167], v1, s[36:39], s40 offen offset:1024 nt
  v_mfma_f32_16x16x32_bf16 v[64:67], v[172:175], v[60:63], v[64:67]
  s_waitcnt vmcnt(4)
  buffer_load_dwordx4 v[168:171], v1, s[36:39], s40 offen offset:2048 nt
  s_waitcnt vmcnt(4)
  buffer_load_dwordx4 v[172:175], v1, s[36:39], s40 offen offset:3072 nt
  s_add_u32 s40, s40, 16384
  s_and_b32 s40, s40, 0x7ffff
  s_waitcnt vmcnt(32)
  v_perm_b32 v56, v38, v38, v48
  v_perm_b32 v57, v38, v38, v49
  v_perm_b32 v58, v38, v38, v50
  v_perm_b32 v59, v38, v38, v51
  v_perm_b32 v60, v38, v38, v52
  v_perm_b32 v61, v38, v38, v53
  v_perm_b32 v62, v38, v38, v54
  v_perm_b32 v63, v38, v38, v55
  v_mfma_f32_16x16x32_bf16 v[64:67], v[176:179], v[56:59], v[64:67]
  v_perm_b32 v56, v39, v39, v48
  v_perm_b32 v57, v39, v39, v49
  v_perm_b32 v58, v39, v39, v50
  v_perm_b32 v59, v39, v39, v51
  v_mfma_f32_16x16x32_bf16 v[64:67], v[180:183], v[60:63], v[64:67]
  v_perm_b32 v60, v39, v39, v52
  v_perm_b32 v61, v39, v39, v53
  v_perm_b32 v62, v39, v39, v54
  v_perm_b32 v63, v39, v39, v55
  v_mfma_f32_16x16x32_bf16 v[64:67], v[184:187], v[56:59], v[64:67]
  s_waitcnt vmcnt(4)
  buffer_load_dwordx4 v[176:179], v1, s[36:39], s40 offen offset:0 nt
  s_waitcnt vmcnt(4)
  buffer_load_dwordx4 v[180:183], v1, s[36:39], s40 offen offset:1024 nt
  v_mfma_f32_16x16x32_bf16 v[64:67], v[188:191], v[60:63], v[64:67]
  s_waitcnt vmcnt(4)
  buffer_load_dwordx4 v[184:187], v1, s[36:39], s40 offen offset:2048 nt
  s_waitcnt vmcnt(4)
  buffer_load_dwordx4 v[188:191], v1, s[36:39], s40 offen offset:3072 nt
  s_add_u32 s40, s40, 16384
  s_and_b32 s40, s40, 0x7ffff
  s_waitcnt lgkmcnt(0)
  s_waitcnt vmcnt(32)
  v_perm_b32 v56, v40, v40, v48
  v_perm_b32 v57, v40, v40, v49
  v_perm_b32 v58, v40, v40, v50
  v_perm_b32 v59, v40, v40, v51
  v_perm_b32 v60, v40, v40, v52
  v_perm_b32 v61, v40, v40, v53
  v_perm_b32 v62, v40, v40, v54
  v_perm_b32 v63, v40, v40, v55
  v_mfma_f32_16x16x32_bf16 v[64:67], v[192:195], v[56:59], v[64:67]
  v_perm_b32 v56, v41, v41, v48
  v_perm_b32 v57, v41, v41, v49
  v_perm_b32 v58, v41, v41, v50
  v_perm_b32 v59, v41, v41, v51
  v_mfma_f32_16x16x32_bf16 v[64:67], v[196:199], v[60:63], v[64:67]
  v_perm_b32 v60, v41, v41, v52
  v_perm_b32 v61, v41, v41, v53
  v_perm_b32 v62, v41, v41, v54
  v_perm_b32 v63, v41, v41, v55
  v_mfma_f32_16x16x32_bf16 v[64:67], v[200:203], v[56:59], v[64:67]
  s_waitcnt vmcnt(4)
  buffer_load_dwordx4 v[192:195], v1, s[36:39], s40 offen offset:0 nt
  s_waitcnt vmcnt(4)
  buffer_load_dwordx4 v[196:199], v1, s[36:39], s40 offen offset:1024 nt
  v_mfma_f32_16x16x32_bf16 v[64:67], v[204:207], v[60:63], v[64:67]
  s_waitcnt vmcnt(4)
  buffer_load_dwordx4 v[200:203], v1, s[36:39], s40 offen offset:2048 nt
  s_waitcnt vmcnt(4)
  buffer_load_dwordx4 v[204:207], v1, s[36:39], s40 offen offset:3072 nt
  s_add_u32 s40, s40, 16384
  s_and_b32 s40, s40, 0x7ffff
  s_waitcnt vmcnt(32)
  v_perm_b32 v56, v42, v42, v48
  v_perm_b32 v57, v42, v42, v49
  v_perm_b32 v58, v42, v42, v50
  v_perm_b32 v59, v42, v42, v51
  v_perm_b32 v60, v42, v42, v52
  v_perm_b32 v61, v42, v42, v53
  v_perm_b32 v62, v42, v42, v54
  v_perm_b32 v63, v42, v42, v55
  v_mfma_f32_16x16x32_bf16 v[64:67], v[208:211], v[56:59], v[64:67]
  v_perm_b32 v56, v43, v43, v48
  v_perm_b32 v57, v43, v43, v49
  v_perm_b32 v58, v43, v43, v50
  v_perm_b32 v59, v43, v43, v51
  v_mfma_f32_16x16x32_bf16 v[64:67], v[212:215], v[60:63], v[64:67]
  v_perm_b32 v60, v43, v43, v52
  v_perm_b32 v61, v43, v43, v53
  v_perm_b32 v62, v43, v43, v54
  v_perm_b32 v63, v43, v43, v55
  v_mfma_f32_16x16x32_bf16 v[64:67], v[216:219], v[56:59], v[64:67]
  s_waitcnt vmcnt(4)
  buffer_load_dwordx4 v[208:211], v1, s[36:39], s40 offen offset:0 nt
  s_waitcnt vmcnt(4)
  buffer_load_dwordx4 v[212:215], v1, s[36:39], s40 offen offset:1024 nt
  v_mfma_f32_16x16x32_bf16 v[64:67], v[220:223], v[60:63], v[64:67]
  s_waitcnt vmcnt(4)
  buffer_load_dwordx4 v[216:219], v1, s[36:39], s40 offen offset:2048 nt
  s_waitcnt vmcnt(4)
  buffer_load_dwordx4 v[220:223], v1, s[36:39], s40 offen offset:3072 nt
  s_add_u32 s40, s40, 16384
  s_and_b32 s40, s40, 0x7ffff
  s_waitcnt vmcnt(32)
  v_perm_b32 v56, v44, v44, v48
  v_perm_b32 v57, v44, v44, v49
  v_perm_b32 v58, v44, v44, v50
  v_perm_b32 v59, v44, v44, v51
  v_perm_b32 v60, v44, v44, v52
  v_perm_b32 v61, v44, v44, v53
  v_perm_b32 v62, v44, v44, v54
  v_perm_b32 v63, v44, v44, v55
  v_mfma_f32_16x16x32_bf16 v[64:67], v[224:227], v[56:59], v[64:67]
  v_perm_b32 v56, v45, v45, v48
  v_perm_b32 v57, v45, v45, v49
  v_perm_b32 v58, v45, v45, v50
  v_perm_b32 v59, v45, v45, v51
  v_mfma_f32_16x16x32_bf16 v[64:67], v[228:231], v[60:63], v[64:67]
  v_perm_b32 v60, v45, v45, v52
  v_perm_b32 v61, v45, v45, v53
  v_perm_b32 v62, v45, v45, v54
  v_perm_b32 v63, v45, v45, v55
  v_mfma_f32_16x16x32_bf16 v[64:67], v[232:235], v[56:59], v[64:67]
  s_waitcnt vmcnt(4)
  buffer_load_dwordx4 v[224:227], v1, s[36:39], s40 offen offset:0 nt
  s_waitcnt vmcnt(4)
  buffer_load_dwordx4 v[228:231], v1, s[36:39], s40 offen offset:1024 nt
  v_mfma_f32_16x16x32_bf16 v[64:67], v[236:239], v[60:63], v[64:67]
  s_waitcnt vmcnt(4)
  buffer_load_dwordx4 v[232:235], v1, s[36:39], s40 offen offset:2048 nt
  s_waitcnt vmcnt(4)
  buffer_load_dwordx4 v[236:239], v1, s[36:39], s40 offen offset:3072 nt
  s_add_u32 s40, s40, 16384
  s_and_b32 s40, s40, 0x7ffff
  s_waitcnt vmcnt(32)
  v_perm_b32 v56, v46, v46, v48
  v_perm_b32 v57, v46, v46, v49
  v_perm_b32 v58, v46, v46, v50
  v_perm_b32 v59, v46, v46, v51
  v_perm_b32 v60, v46, v46, v52
  v_perm_b32 v61, v46, v46, v53
  v_perm_b32 v62, v46, v46, v54
  v_perm_b32 v63, v46, v46, v55
  v_mfma_f32_16x16x32_bf16 v[64:67], v[240:243], v[56:59], v[64:67]
  v_perm_b32 v56, v47, v47, v48
  v_perm_b32 v57, v47, v47, v49
  v_perm_b32 v58, v47, v47, v50
  v_perm_b32 v59, v47, v47, v51
  v_mfma_f32_16x16x32_bf16 v[64:67], v[244:247], v[60:63], v[64:67]
  v_perm_b32 v60, v47, v47, v52
  v_perm_b32 v61, v47, v47, v53
  v_perm_b32 v62, v47, v47, v54
  v_perm_b32 v63, v47, v47, v55
  v_mfma_f32_16x16x32_bf16 v[64:67], v[248:251], v[56:59], v[64:67]
  s_waitcnt vmcnt(4)
  buffer_load_dwordx4 v[240:243], v1, s[36:39], s40 offen offset:0 nt
  s_waitcnt vmcnt(4)
  buffer_load_dwordx4 v[244:247], v1, s[36:39], s40 offen offset:1024 nt
  v_mfma_f32_16x16x32_bf16 v[64:67], v[252:255], v[60:63], v[64:67]
  s_waitcnt vmcnt(4)
  buffer_load_dwordx4 v[248:251], v1, s[36:39], s40 offen offset:2048 nt
  s_waitcnt vmcnt(4)
  buffer_load_dwordx4 v[252:255], v1, s[36:39], s40 offen offset:3072 nt
  s_add_u32 s40, s40, 16384
  s_and_b32 s40, s40, 0x7ffff
  ds_bpermute_b32 v32, v72, v69 offset:0
  ds_bpermute_b32 v33, v72, v69 offset:32
  ds_bpermute_b32 v34, v72, v69 offset:16
  ds_bpermute_b32 v35, v72, v69 offset:48
  ds_bpermute_b32 v36, v72, v69 offset:8
  ds_bpermute_b32 v37, v72, v69 offset:40
  ds_bpermute_b32 v38, v72, v69 offset:24
  ds_bpermute_b32 v39, v72, v69 offset:56
  s_waitcnt lgkmcnt(0)
  s_waitcnt vmcnt(32)
  v_perm_b32 v56, v32, v32, v48
  v_perm_b32 v57, v32, v32, v49
  v_perm_b32 v58, v32, v32, v50
  v_perm_b32 v59, v32, v32, v51
  v_perm_b32 v60, v32, v32, v52
  v_perm_b32 v61, v32, v32, v53
  v_perm_b32 v62, v32, v32, v54
  v_perm_b32 v63, v32, v32, v55
  v_mfma_f32_16x16x32_bf16 v[64:67], v[76:79], v[56:59], v[64:67]
  v_perm_b32 v56, v33, v33, v48
  v_perm_b32 v57, v33, v33, v49
  v_perm_b32 v58, v33, v33, v50
  v_perm_b32 v59, v33, v33, v51
  v_mfma_f32_16x16x32_bf16 v[64:67], v[80:83], v[60:63], v[64:67]
  v_perm_b32 v60, v33, v33, v52
  v_perm_b32 v61, v33, v33, v53
  v_perm_b32 v62, v33, v33, v54
  v_perm_b32 v63, v33, v33, v55
  v_mfma_f32_16x16x32_bf16 v[64:67], v[84:87], v[56:59], v[64:67]
  s_waitcnt vmcnt(4)
  buffer_load_dwordx4 v[76:79], v1, s[36:39], s40 offen offset:0 nt
  s_waitcnt vmcnt(4)
  buffer_load_dwordx4 v[80:83], v1, s[36:39], s40 offen offset:1024 nt
  v_mfma_f32_16x16x32_bf16 v[64:67], v[88:91], v[60:63], v[64:67]
  s_waitcnt vmcnt(4)
  buffer_load_dwordx4 v[84:87], v1, s[36:39], s40 offen offset:2048 nt
  s_waitcnt vmcnt(4)
  buffer_load_dwordx4 v[88:91], v1, s[36:39], s40 offen offset:3072 nt
  s_add_u32 s40, s40, 16384
  s_and_b32 s40, s40, 0x7ffff
  ds_bpermute_b32 v40, v72, v69 offset:4
  ds_bpermute_b32 v41, v72, v69 offset:36
  ds_bpermute_b32 v42, v72, v69 offset:20
  ds_bpermute_b32 v43, v72, v69 offset:52
  ds_bpermute_b32 v44, v72, v69 offset:12
  ds_bpermute_b32 v45, v72, v69 offset:44
  ds_bpermute_b32 v46, v72, v69 offset:28
  ds_bpermute_b32 v47, v72, v69 offset:60
  s_waitcnt vmcnt(32)
  v_perm_b32 v56, v34, v34, v48
  v_perm_b32 v57, v34, v34, v49
  v_perm_b32 v58, v34, v34, v50
  v_perm_b32 v59, v34, v34, v51
  v_perm_b32 v60, v34, v34, v52
  v_perm_b32 v61, v34, v34, v53
  v_perm_b32 v62, v34, v34, v54
  v_perm_b32 v63, v34, v34, v55
  v_mfma_f32_16x16x32_bf16 v[64:67], v[128:131], v[56:59], v[64:67]
  v_perm_b32 v56, v35, v35, v48
  v_perm_b32 v57, v35, v35, v49
  v_perm_b32 v58, v35, v35, v50
  v_perm_b32 v59, v35, v35, v51
  v_mfma_f32_16x16x32_bf16 v[64:67], v[132:135], v[60:63], v[64:67]
  v_perm_b32 v60, v35, v35, v52
  v_perm_b32 v61, v35, v35, v53
  v_perm_b32 v62, v35, v35, v54
  v_perm_b32 v63, v35, v35, v55
  v_mfma_f32_16x16x32_bf16 v[64:67], v[136:139], v[56:59], v[64:67]
  s_waitcnt vmcnt(4)
  buffer_load_dwordx4 v[128:131], v1, s[36:39], s40 offen offset:0 nt
  s_waitcnt vmcnt(4)
  buffer_load_dwordx4 v[132:135], v1, s[36:39], s40 offen offset:1024 nt
  v_mfma_f32_16x16x32_bf16 v[64:67], v[140:143], v[60:63], v[64:67]
  s_waitcnt vmcnt(4)
  buffer_load_dwordx4 v[136:139], v1, s[36:39], s40 offen offset:2048 nt
  s_waitcnt vmcnt(4)
  buffer_load_dwordx4 v[140:143], v1, s[36:39], s40 offen offset:3072 nt
  s_add_u32 s40, s40, 16384
  s_and_b32 s40, s40, 0x7ffff
  s_waitcnt vmcnt(32)
  v_perm_b32 v56, v36, v36, v48
  v_perm_b32 v57, v36, v36, v49
  v_perm_b32 v58, v36, v36, v50
  v_perm_b32 v59, v36, v36, v51
  v_perm_b32 v60, v36, v36, v52
  v_perm_b32 v61, v36, v36, v53
  v_perm_b32 v62, v36, v36, v54
  v_perm_b32 v63, v36, v36, v55
  v_mfma_f32_16x16x32_bf16 v[64:67], v[144:147], v[56:59], v[64:67]
  v_perm_b32 v56, v37, v37, v48
  v_perm_b32 v57, v37, v37, v49
  v_perm_b32 v58, v37, v37, v50
  v_perm_b32 v59, v37, v37, v51
  v_mfma_f32_16x16x32_bf16 v[64:67], v[148:151], v[60:63], v[64:67]
  v_perm_b32 v60, v37, v37, v52
  v_perm_b32 v61, v37, v37, v53
  v_perm_b32 v62, v37, v37, v54
  v_perm_b32 v63, v37, v37, v55
  v_mfma_f32_16x16x32_bf16 v[64:67], v[152:155], v[56:59], v[64:67]
  s_waitcnt vmcnt(4)
  buffer_load_dwordx4 v[144:147], v1, s[36:39], s40 offen offset:0 nt
  s_waitcnt vmcnt(4)
  buffer_load_dwordx4 v[148:151], v1, s[36:39], s40 offen offset:1024 nt
  v_mfma_f32_16x16x32_bf16 v[64:67], v[156:159], v[60:63], v[64:67]
  s_waitcnt vmcnt(4)
  buffer_load_dwordx4 v[152:155], v1, s[36:39], s40 offen offset:2048 nt
  s_waitcnt vmcnt(4)
  buffer_load_dwordx4 v[156:159], v1, s[36:39], s40 offen offset:3072 nt
  s_add_u32 s40, s40, 16384
  s_and_b32 s40, s40, 0x7ffff
  s_waitcnt vmcnt(32)
  v_perm_b32 v56, v38, v38, v48
  v_perm_b32 v57, v38, v38, v49
  v_perm_b32 v58, v38, v38, v50
  v_perm_b32 v59, v38, v38, v51
  v_perm_b32 v60, v38, v38, v52
  v_perm_b32 v61, v38, v38, v53
  v_perm_b32 v62, v38, v38, v54
  v_perm_b32 v63, v38, v38, v55
  v_mfma_f32_16x16x32_bf16 v[64:67], v[160:163], v[56:59], v[64:67]
  v_perm_b32 v56, v39, v39, v48
  v_perm_b32 v57, v39, v39, v49
  v_perm_b32 v58, v39, v39, v50
  v_perm_b32 v59, v39, v39, v51
  v_mfma_f32_16x16x32_bf16 v[64:67], v[164:167], v[60:63], v[64:67]
  v_perm_b32 v60, v39, v39, v52
  v_perm_b32 v61, v39, v39, v53
  v_perm_b32 v62, v39, v39, v54
  v_perm_b32 v63, v39, v39, v55
  v_mfma_f32_16x16x32_bf16 v[64:67], v[168:171], v[56:59], v[64:67]
  s_waitcnt vmcnt(4)
  buffer_load_dwordx4 v[160:163], v1, s[36:39], s40 offen offset:0 nt
  s_waitcnt vmcnt(4)
  buffer_load_dwordx4 v[164:167], v1, s[36:39], s40 offen offset:1024 nt
  v_mfma_f32_16x16x32_bf16 v[64:67], v[172:175], v[60:63], v[64:67]
  s_waitcnt vmcnt(4)
  buffer_load_dwordx4 v[168:171], v1, s[36:39], s40 offen offset:2048 nt
  s_waitcnt vmcnt(4)
  buffer_load_dwordx4 v[172:175], v1, s[36:39], s40 offen offset:3072 nt
  s_add_u32 s40, s40, 16384
  s_and_b32 s40, s40, 0x7ffff
  s_waitcnt lgkmcnt(0)
  s_waitcnt vmcnt(32)
  v_perm_b32 v56, v40, v40, v48
  v_perm_b32 v57, v40, v40, v49
  v_perm_b32 v58, v40, v40, v50
  v_perm_b32 v59, v40, v40, v51
  v_perm_b32 v60, v40, v40, v52
  v_perm_b32 v61, v40, v40, v53
  v_perm_b32 v62, v40, v40, v54
  v_perm_b32 v63, v40, v40, v55
  v_mfma_f32_16x16x32_bf16 v[64:67], v[176:179], v[56:59], v[64:67]
  v_perm_b32 v56, v41, v41, v48
  v_perm_b32 v57, v41, v41, v49
  v_perm_b32 v58, v41, v41, v50
  v_perm_b32 v59, v41, v41, v51
  v_mfma_f32_16x16x32_bf16 v[64:67], v[180:183], v[60:63], v[64:67]
  v_perm_b32 v60, v41, v41, v52
  v_perm_b32 v61, v41, v41, v53
  v_perm_b32 v62, v41, v41, v54
  v_perm_b32 v63, v41, v41, v55
  v_mfma_f32_16x16x32_bf16 v[64:67], v[184:187], v[56:59], v[64:67]
  s_waitcnt vmcnt(4)
  buffer_load_dwordx4 v[176:179], v1, s[36:39], s40 offen offset:0 nt
  s_waitcnt vmcnt(4)
  buffer_load_dwordx4 v[180:183], v1, s[36:39], s40 offen offset:1024 nt
  v_mfma_f32_16x16x32_bf16 v[64:67], v[188:191], v[60:63], v[64:67]
  s_waitcnt vmcnt(4)
  buffer_load_dwordx4 v[184:187], v1, s[36:39], s40 offen offset:2048 nt
  s_waitcnt vmcnt(4)
  buffer_load_dwordx4 v[188:191], v1, s[36:39], s40 offen offset:3072 nt
  s_add_u32 s40, s40, 16384
  s_and_b32 s40, s40, 0x7ffff
  s_waitcnt vmcnt(32)
  v_perm_b32 v56, v42, v42, v48
  v_perm_b32 v57, v42, v42, v49
  v_perm_b32 v58, v42, v42, v50
  v_perm_b32 v59, v42, v42, v51
  v_perm_b32 v60, v42, v42, v52
  v_perm_b32 v61, v42, v42, v53
  v_perm_b32 v62, v42, v42, v54
  v_perm_b32 v63, v42, v42, v55
  v_mfma_f32_16x16x32_bf16 v[64:67], v[192:195], v[56:59], v[64:67]
  v_perm_b32 v56, v43, v43, v48
  v_perm_b32 v57, v43, v43, v49
  v_perm_b32 v58, v43, v43, v50
  v_perm_b32 v59, v43, v43, v51
  v_mfma_f32_16x16x32_bf16 v[64:67], v[196:199], v[60:63], v[64:67]
  v_perm_b32 v60, v43, v43, v52
  v_perm_b32 v61, v43, v43, v53
  v_perm_b32 v62, v43, v43, v54
  v_perm_b32 v63, v43, v43, v55
  v_mfma_f32_16x16x32_bf16 v[64:67], v[200:203], v[56:59], v[64:67]
  s_waitcnt vmcnt(4)
  buffer_load_dwordx4 v[192:195], v1, s[36:39], s40 offen offset:0 nt
  s_waitcnt vmcnt(4)
  buffer_load_dwordx4 v[196:199], v1, s[36:39], s40 offen offset:1024 nt
  v_mfma_f32_16x16x32_bf16 v[64:67], v[204:207], v[60:63], v[64:67]
  s_waitcnt vmcnt(4)
  buffer_load_dwordx4 v[200:203], v1, s[36:39], s40 offen offset:2048 nt
  s_waitcnt vmcnt(4)
  buffer_load_dwordx4 v[204:207], v1, s[36:39], s40 offen offset:3072 nt
  s_add_u32 s40, s40, 16384
  s_and_b32 s40, s40, 0x7ffff
  s_waitcnt vmcnt(32)
  v_perm_b32 v56, v44, v44, v48
  v_perm_b32 v57, v44, v44, v49
  v_perm_b32 v58, v44, v44, v50
  v_perm_b32 v59, v44, v44, v51
  v_perm_b32 v60, v44, v44, v52
  v_perm_b32 v61, v44, v44, v53
  v_perm_b32 v62, v44, v44, v54
  v_perm_b32 v63, v44, v44, v55
  v_mfma_f32_16x16x32_bf16 v[64:67], v[208:211], v[56:59], v[64:67]
  v_perm_b32 v56, v45, v45, v48
  v_perm_b32 v57, v45, v45, v49
  v_perm_b32 v58, v45, v45, v50
  v_perm_b32 v59, v45, v45, v51
  v_mfma_f32_16x16x32_bf16 v[64:67], v[212:215], v[60:63], v[64:67]
  v_perm_b32 v60, v45, v45, v52
  v_perm_b32 v61, v45, v45, v53
  v_perm_b32 v62, v45, v45, v54
  v_perm_b32 v63, v45, v45, v55
  v_mfma_f32_16x16x32_bf16 v[64:67], v[216:219], v[56:59], v[64:67]
  s_waitcnt vmcnt(4)
  buffer_load_dwordx4 v[208:211], v1, s[36:39], s40 offen offset:0 nt
  s_waitcnt vmcnt(4)
  buffer_load_dwordx4 v[212:215], v1, s[36:39], s40 offen offset:1024 nt
  v_mfma_f32_16x16x32_bf16 v[64:67], v[220:223], v[60:63], v[64:67]
  s_waitcnt vmcnt(4)
  buffer_load_dwordx4 v[216:219], v1, s[36:39], s40 offen offset:2048 nt
  s_waitcnt vmcnt(4)
  buffer_load_dwordx4 v[220:223], v1, s[36:39], s40 offen offset:3072 nt
  s_add_u32 s40, s40, 16384
  s_and_b32 s40, s40, 0x7ffff
  s_waitcnt vmcnt(32)
  v_perm_b32 v56, v46, v46, v48
  v_perm_b32 v57, v46, v46, v49
  v_perm_b32 v58, v46, v46, v50
  v_perm_b32 v59, v46, v46, v51
  v_perm_b32 v60, v46, v46, v52
  v_perm_b32 v61, v46, v46, v53
  v_perm_b32 v62, v46, v46, v54
  v_perm_b32 v63, v46, v46, v55
  v_mfma_f32_16x16x32_bf16 v[64:67], v[224:227], v[56:59], v[64:67]
  v_perm_b32 v56, v47, v47, v48
  v_perm_b32 v57, v47, v47, v49
  v_perm_b32 v58, v47, v47, v50
  v_perm_b32 v59, v47, v47, v51
  v_mfma_f32_16x16x32_bf16 v[64:67], v[228:231], v[60:63], v[64:67]
  v_perm_b32 v60, v47, v47, v52
  v_perm_b32 v61, v47, v47, v53
  v_perm_b32 v62, v47, v47, v54
  v_perm_b32 v63, v47, v47, v55
  v_mfma_f32_16x16x32_bf16 v[64:67], v[232:235], v[56:59], v[64:67]
  s_waitcnt vmcnt(4)
  buffer_load_dwordx4 v[224:227], v1, s[36:39], s40 offen offset:0 nt
  s_waitcnt vmcnt(4)
  buffer_load_dwordx4 v[228:231], v1, s[36:39], s40 offen offset:1024 nt
  v_mfma_f32_16x16x32_bf16 v[64:67], v[236:239], v[60:63], v[64:67]
  s_waitcnt vmcnt(4)
  buffer_load_dwordx4 v[232:235], v1, s[36:39], s40 offen offset:2048 nt
  s_waitcnt vmcnt(4)
  buffer_load_dwordx4 v[236:239], v1, s[36:39], s40 offen offset:3072 nt
  s_add_u32 s40, s40, 16384
  s_and_b32 s40, s40, 0x7ffff
  v_mov_b32 v15, 1
  s_mov_b64 exec, 1
  ds_add_u32 v31, v15 offset:2716
  s_mov_b64 exec, -1
  v_mov_b32 v15, 1
  s_mov_b64 exec, 1
  ds_add_u32 v31, v15 offset:2712
  s_mov_b64 exec, -1
  ds_bpermute_b32 v32, v72, v70 offset:0
  ds_bpermute_b32 v33, v72, v70 offset:32
  ds_bpermute_b32 v34, v72, v70 offset:16
  ds_bpermute_b32 v35, v72, v70 offset:48
  ds_bpermute_b32 v36, v72, v70 offset:8
  ds_bpermute_b32 v37, v72, v70 offset:40
  ds_bpermute_b32 v38, v72, v70 offset:24
  ds_bpermute_b32 v39, v72, v70 offset:56
  s_waitcnt lgkmcnt(0)
  s_waitcnt vmcnt(32)
  v_perm_b32 v56, v32, v32, v48
  v_perm_b32 v57, v32, v32, v49
  v_perm_b32 v58, v32, v32, v50
  v_perm_b32 v59, v32, v32, v51
  v_perm_b32 v60, v32, v32, v52
  v_perm_b32 v61, v32, v32, v53
  v_perm_b32 v62, v32, v32, v54
  v_perm_b32 v63, v32, v32, v55
  v_mfma_f32_16x16x32_bf16 v[64:67], v[240:243], v[56:59], v[64:67]
  v_perm_b32 v56, v33, v33, v48
  v_perm_b32 v57, v33, v33, v49
  v_perm_b32 v58, v33, v33, v50
  v_perm_b32 v59, v33, v33, v51
  v_mfma_f32_16x16x32_bf16 v[64:67], v[244:247], v[60:63], v[64:67]
  v_perm_b32 v60, v33, v33, v52
  v_perm_b32 v61, v33, v33, v53
  v_perm_b32 v62, v33, v33, v54
  v_perm_b32 v63, v33, v33, v55
  v_mfma_f32_16x16x32_bf16 v[64:67], v[248:251], v[56:59], v[64:67]
  s_waitcnt vmcnt(7)
  buffer_load_dwordx4 v[240:243], v1, s[36:39], s40 offen offset:0 nt
  s_waitcnt vmcnt(7)
  buffer_load_dwordx4 v[244:247], v1, s[36:39], s40 offen offset:1024 nt
  v_mfma_f32_16x16x32_bf16 v[64:67], v[252:255], v[60:63], v[64:67]
  s_waitcnt vmcnt(7)
  buffer_load_dwordx4 v[248:251], v1, s[36:39], s40 offen offset:2048 nt
  s_waitcnt vmcnt(7)
  buffer_load_dwordx4 v[252:255], v1, s[36:39], s40 offen offset:3072 nt
  s_add_u32 s40, s40, 16384
  s_and_b32 s40, s40, 0x7ffff
  ds_bpermute_b32 v40, v72, v70 offset:4
  ds_bpermute_b32 v41, v72, v70 offset:36
  ds_bpermute_b32 v42, v72, v70 offset:20
  ds_bpermute_b32 v43, v72, v70 offset:52
  ds_bpermute_b32 v44, v72, v70 offset:12
  ds_bpermute_b32 v45, v72, v70 offset:44
  ds_bpermute_b32 v46, v72, v70 offset:28
  ds_bpermute_b32 v47, v72, v70 offset:60
  s_waitcnt vmcnt(32)
  v_perm_b32 v56, v34, v34, v48
  v_perm_b32 v57, v34, v34, v49
  v_perm_b32 v58, v34, v34, v50
  v_perm_b32 v59, v34, v34, v51
  v_perm_b32 v60, v34, v34, v52
  v_perm_b32 v61, v34, v34, v53
  v_perm_b32 v62, v34, v34, v54
  v_perm_b32 v63, v34, v34, v55
  v_mfma_f32_16x16x32_bf16 v[64:67], v[76:79], v[56:59], v[64:67]
  v_perm_b32 v56, v35, v35, v48
  v_perm_b32 v57, v35, v35, v49
  v_perm_b32 v58, v35, v35, v50
  v_perm_b32 v59, v35, v35, v51
  v_mfma_f32_16x16x32_bf16 v[64:67], v[80:83], v[60:63], v[64:67]
  v_perm_b32 v60, v35, v35, v52
  v_perm_b32 v61, v35, v35, v53
  v_perm_b32 v62, v35, v35, v54
  v_perm_b32 v63, v35, v35, v55
  v_mfma_f32_16x16x32_bf16 v[64:67], v[84:87], v[56:59], v[64:67]
  s_waitcnt vmcnt(7)
  buffer_load_dwordx4 v[76:79], v1, s[36:39], s40 offen offset:0 nt
  s_waitcnt vmcnt(7)
  buffer_load_dwordx4 v[80:83], v1, s[36:39], s40 offen offset:1024 nt
  v_mfma_f32_16x16x32_bf16 v[64:67], v[88:91], v[60:63], v[64:67]
  s_waitcnt vmcnt(7)
  buffer_load_dwordx4 v[84:87], v1, s[36:39], s40 offen offset:2048 nt
  s_waitcnt vmcnt(7)
  buffer_load_dwordx4 v[88:91], v1, s[36:39], s40 offen offset:3072 nt
  s_add_u32 s40, s40, 16384
  s_and_b32 s40, s40, 0x7ffff
  s_waitcnt vmcnt(32)
  v_perm_b32 v56, v36, v36, v48
  v_perm_b32 v57, v36, v36, v49
  v_perm_b32 v58, v36, v36, v50
  v_perm_b32 v59, v36, v36, v51
  v_perm_b32 v60, v36, v36, v52
  v_perm_b32 v61, v36, v36, v53
  v_perm_b32 v62, v36, v36, v54
  v_perm_b32 v63, v36, v36, v55
  v_mfma_f32_16x16x32_bf16 v[64:67], v[128:131], v[56:59], v[64:67]
  v_perm_b32 v56, v37, v37, v48
  v_perm_b32 v57, v37, v37, v49
  v_perm_b32 v58, v37, v37, v50
  v_perm_b32 v59, v37, v37, v51
  v_mfma_f32_16x16x32_bf16 v[64:67], v[132:135], v[60:63], v[64:67]
  v_perm_b32 v60, v37, v37, v52
  v_perm_b32 v61, v37, v37, v53
  v_perm_b32 v62, v37, v37, v54
  v_perm_b32 v63, v37, v37, v55
  v_mfma_f32_16x16x32_bf16 v[64:67], v[136:139], v[56:59], v[64:67]
  s_waitcnt vmcnt(7)
  buffer_load_dwordx4 v[128:131], v1, s[36:39], s40 offen offset:0 nt
  s_waitcnt vmcnt(7)
  buffer_load_dwordx4 v[132:135], v1, s[36:39], s40 offen offset:1024 nt
  v_mfma_f32_16x16x32_bf16 v[64:67], v[140:143], v[60:63], v[64:67]
  s_waitcnt vmcnt(7)
  buffer_load_dwordx4 v[136:139], v1, s[36:39], s40 offen offset:2048 nt
  s_waitcnt vmcnt(7)
  buffer_load_dwordx4 v[140:143], v1, s[36:39], s40 offen offset:3072 nt
  s_add_u32 s40, s40, 16384
  s_and_b32 s40, s40, 0x7ffff
  s_waitcnt vmcnt(32)
  v_perm_b32 v56, v38, v38, v48
  v_perm_b32 v57, v38, v38, v49
  v_perm_b32 v58, v38, v38, v50
  v_perm_b32 v59, v38, v38, v51
  v_perm_b32 v60, v38, v38, v52
  v_perm_b32 v61, v38, v38, v53
  v_perm_b32 v62, v38, v38, v54
  v_perm_b32 v63, v38, v38, v55
  v_mfma_f32_16x16x32_bf16 v[64:67], v[144:147], v[56:59], v[64:67]
  v_perm_b32 v56, v39, v39, v48
  v_perm_b32 v57, v39, v39, v49
  v_perm_b32 v58, v39, v39, v50
  v_perm_b32 v59, v39, v39, v51
  v_mfma_f32_16x16x32_bf16 v[64:67], v[148:151], v[60:63], v[64:67]
  v_perm_b32 v60, v39, v39, v52
  v_perm_b32 v61, v39, v39, v53
  v_perm_b32 v62, v39, v39, v54
  v_perm_b32 v63, v39, v39, v55
  v_mfma_f32_16x16x32_bf16 v[64:67], v[152:155], v[56:59], v[64:67]
  s_waitcnt vmcnt(7)
  buffer_load_dwordx4 v[144:147], v1, s[36:39], s40 offen offset:0 nt
  s_waitcnt vmcnt(7)
  buffer_load_dwordx4 v[148:151], v1, s[36:39], s40 offen offset:1024 nt
  v_mfma_f32_16x16x32_bf16 v[64:67], v[156:159], v[60:63], v[64:67]
  s_waitcnt vmcnt(7)
  buffer_load_dwordx4 v[152:155], v1, s[36:39], s40 offen offset:2048 nt
  s_waitcnt vmcnt(7)
  buffer_load_dwordx4 v[156:159], v1, s[36:39], s40 offen offset:3072 nt
  s_add_u32 s40, s40, 16384
  s_and_b32 s40, s40, 0x7ffff
  s_waitcnt lgkmcnt(0)
  s_waitcnt vmcnt(32)
  v_perm_b32 v56, v40, v40, v48
  v_perm_b32 v57, v40, v40, v49
  v_perm_b32 v58, v40, v40, v50
  v_perm_b32 v59, v40, v40, v51
  v_perm_b32 v60, v40, v40, v52
  v_perm_b32 v61, v40, v40, v53
  v_perm_b32 v62, v40, v40, v54
  v_perm_b32 v63, v40, v40, v55
  v_mfma_f32_16x16x32_bf16 v[64:67], v[160:163], v[56:59], v[64:67]
  v_perm_b32 v56, v41, v41, v48
  v_perm_b32 v57, v41, v41, v49
  v_perm_b32 v58, v41, v41, v50
  v_perm_b32 v59, v41, v41, v51
  v_mfma_f32_16x16x32_bf16 v[64:67], v[164:167], v[60:63], v[64:67]
  v_perm_b32 v60, v41, v41, v52
  v_perm_b32 v61, v41, v41, v53
  v_perm_b32 v62, v41, v41, v54
  v_perm_b32 v63, v41, v41, v55
  v_mfma_f32_16x16x32_bf16 v[64:67], v[168:171], v[56:59], v[64:67]
  s_waitcnt vmcnt(7)
  buffer_load_dwordx4 v[160:163], v1, s[36:39], s40 offen offset:0 nt
  s_waitcnt vmcnt(7)
  buffer_load_dwordx4 v[164:167], v1, s[36:39], s40 offen offset:1024 nt
  v_mfma_f32_16x16x32_bf16 v[64:67], v[172:175], v[60:63], v[64:67]
  s_waitcnt vmcnt(7)
  buffer_load_dwordx4 v[168:171], v1, s[36:39], s40 offen offset:2048 nt
  s_waitcnt vmcnt(7)
  buffer_load_dwordx4 v[172:175], v1, s[36:39], s40 offen offset:3072 nt
  s_add_u32 s40, s40, 16384
  s_and_b32 s40, s40, 0x7ffff
  s_waitcnt vmcnt(32)
  v_perm_b32 v56, v42, v42, v48
  v_perm_b32 v57, v42, v42, v49
  v_perm_b32 v58, v42, v42, v50
  v_perm_b32 v59, v42, v42, v51
  v_perm_b32 v60, v42, v42, v52
  v_perm_b32 v61, v42, v42, v53
  v_perm_b32 v62, v42, v42, v54
  v_perm_b32 v63, v42, v42, v55
  v_mfma_f32_16x16x32_bf16 v[64:67], v[176:179], v[56:59], v[64:67]
  v_perm_b32 v56, v43, v43, v48
  v_perm_b32 v57, v43, v43, v49
  v_perm_b32 v58, v43, v43, v50
  v_perm_b32 v59, v43, v43, v51
  v_mfma_f32_16x16x32_bf16 v[64:67], v[180:183], v[60:63], v[64:67]
  v_perm_b32 v60, v43, v43, v52
  v_perm_b32 v61, v43, v43, v53
  v_perm_b32 v62, v43, v43, v54
  v_perm_b32 v63, v43, v43, v55
  v_mfma_f32_16x16x32_bf16 v[64:67], v[184:187], v[56:59], v[64:67]
  s_waitcnt vmcnt(7)
  buffer_load_dwordx4 v[176:179], v1, s[36:39], s40 offen offset:0 nt
  s_waitcnt vmcnt(7)
  buffer_load_dwordx4 v[180:183], v1, s[36:39], s40 offen offset:1024 nt
  v_mfma_f32_16x16x32_bf16 v[64:67], v[188:191], v[60:63], v[64:67]
  s_waitcnt vmcnt(7)
  buffer_load_dwordx4 v[184:187], v1, s[36:39], s40 offen offset:2048 nt
  s_waitcnt vmcnt(7)
  buffer_load_dwordx4 v[188:191], v1, s[36:39], s40 offen offset:3072 nt
  s_add_u32 s40, s40, 16384
  s_and_b32 s40, s40, 0x7ffff
  s_waitcnt vmcnt(32)
  v_perm_b32 v56, v44, v44, v48
  v_perm_b32 v57, v44, v44, v49
  v_perm_b32 v58, v44, v44, v50
  v_perm_b32 v59, v44, v44, v51
  v_perm_b32 v60, v44, v44, v52
  v_perm_b32 v61, v44, v44, v53
  v_perm_b32 v62, v44, v44, v54
  v_perm_b32 v63, v44, v44, v55
  v_mfma_f32_16x16x32_bf16 v[64:67], v[192:195], v[56:59], v[64:67]
  v_perm_b32 v56, v45, v45, v48
  v_perm_b32 v57, v45, v45, v49
  v_perm_b32 v58, v45, v45, v50
  v_perm_b32 v59, v45, v45, v51
  v_mfma_f32_16x16x32_bf16 v[64:67], v[196:199], v[60:63], v[64:67]
  v_perm_b32 v60, v45, v45, v52
  v_perm_b32 v61, v45, v45, v53
  v_perm_b32 v62, v45, v45, v54
  v_perm_b32 v63, v45, v45, v55
  v_mfma_f32_16x16x32_bf16 v[64:67], v[200:203], v[56:59], v[64:67]
  s_waitcnt vmcnt(7)
  buffer_load_dwordx4 v[192:195], v1, s[36:39], s40 offen offset:0 nt
  s_waitcnt vmcnt(7)
  buffer_load_dwordx4 v[196:199], v1, s[36:39], s40 offen offset:1024 nt
  v_mfma_f32_16x16x32_bf16 v[64:67], v[204:207], v[60:63], v[64:67]
  s_waitcnt vmcnt(7)
  buffer_load_dwordx4 v[200:203], v1, s[36:39], s40 offen offset:2048 nt
  s_waitcnt vmcnt(7)
  buffer_load_dwordx4 v[204:207], v1, s[36:39], s40 offen offset:3072 nt
  s_add_u32 s40, s40, 16384
  s_and_b32 s40, s40, 0x7ffff
  s_waitcnt vmcnt(32)
  v_perm_b32 v56, v46, v46, v48
  v_perm_b32 v57, v46, v46, v49
  v_perm_b32 v58, v46, v46, v50
  v_perm_b32 v59, v46, v46, v51
  v_perm_b32 v60, v46, v46, v52
  v_perm_b32 v61, v46, v46, v53
  v_perm_b32 v62, v46, v46, v54
  v_perm_b32 v63, v46, v46, v55
  v_mfma_f32_16x16x32_bf16 v[64:67], v[208:211], v[56:59], v[64:67]
  v_perm_b32 v56, v47, v47, v48
  v_perm_b32 v57, v47, v47, v49
  v_perm_b32 v58, v47, v47, v50
  v_perm_b32 v59, v47, v47, v51
  v_mfma_f32_16x16x32_bf16 v[64:67], v[212:215], v[60:63], v[64:67]
  v_perm_b32 v60, v47, v47, v52
  v_perm_b32 v61, v47, v47, v53
  v_perm_b32 v62, v47, v47, v54
  v_perm_b32 v63, v47, v47, v55
  v_mfma_f32_16x16x32_bf16 v[64:67], v[216:219], v[56:59], v[64:67]
  s_nop 0
  v_mfma_f32_16x16x32_bf16 v[64:67], v[220:223], v[60:63], v[64:67]
  ds_bpermute_b32 v32, v72, v71 offset:0
  ds_bpermute_b32 v33, v72, v71 offset:32
  ds_bpermute_b32 v34, v72, v71 offset:16
  ds_bpermute_b32 v35, v72, v71 offset:48
  ds_bpermute_b32 v36, v72, v71 offset:8
  ds_bpermute_b32 v37, v72, v71 offset:40
  ds_bpermute_b32 v38, v72, v71 offset:24
  ds_bpermute_b32 v39, v72, v71 offset:56
  s_waitcnt lgkmcnt(0)
  s_waitcnt vmcnt(28)
  v_perm_b32 v56, v32, v32, v48
  v_perm_b32 v57, v32, v32, v49
  v_perm_b32 v58, v32, v32, v50
  v_perm_b32 v59, v32, v32, v51
  v_perm_b32 v60, v32, v32, v52
  v_perm_b32 v61, v32, v32, v53
  v_perm_b32 v62, v32, v32, v54
  v_perm_b32 v63, v32, v32, v55
  v_mfma_f32_16x16x32_bf16 v[64:67], v[224:227], v[56:59], v[64:67]
  v_perm_b32 v56, v33, v33, v48
  v_perm_b32 v57, v33, v33, v49
  v_perm_b32 v58, v33, v33, v50
  v_perm_b32 v59, v33, v33, v51
  v_mfma_f32_16x16x32_bf16 v[64:67], v[228:231], v[60:63], v[64:67]
  v_perm_b32 v60, v33, v33, v52
  v_perm_b32 v61, v33, v33, v53
  v_perm_b32 v62, v33, v33, v54
  v_perm_b32 v63, v33, v33, v55
  v_mfma_f32_16x16x32_bf16 v[64:67], v[232:235], v[56:59], v[64:67]
  s_nop 0
  v_mfma_f32_16x16x32_bf16 v[64:67], v[236:239], v[60:63], v[64:67]
  ds_bpermute_b32 v40, v72, v71 offset:4
  ds_bpermute_b32 v41, v72, v71 offset:36
  ds_bpermute_b32 v42, v72, v71 offset:20
  ds_bpermute_b32 v43, v72, v71 offset:52
  ds_bpermute_b32 v44, v72, v71 offset:12
  ds_bpermute_b32 v45, v72, v71 offset:44
  ds_bpermute_b32 v46, v72, v71 offset:28
  ds_bpermute_b32 v47, v72, v71 offset:60
  s_waitcnt vmcnt(24)
  v_perm_b32 v56, v34, v34, v48
  v_perm_b32 v57, v34, v34, v49
  v_perm_b32 v58, v34, v34, v50
  v_perm_b32 v59, v34, v34, v51
  v_perm_b32 v60, v34, v34, v52
  v_perm_b32 v61, v34, v34, v53
  v_perm_b32 v62, v34, v34, v54
  v_perm_b32 v63, v34, v34, v55
  v_mfma_f32_16x16x32_bf16 v[64:67], v[240:243], v[56:59], v[64:67]
  v_perm_b32 v56, v35, v35, v48
  v_perm_b32 v57, v35, v35, v49
  v_perm_b32 v58, v35, v35, v50
  v_perm_b32 v59, v35, v35, v51
  v_mfma_f32_16x16x32_bf16 v[64:67], v[244:247], v[60:63], v[64:67]
  v_perm_b32 v60, v35, v35, v52
  v_perm_b32 v61, v35, v35, v53
  v_perm_b32 v62, v35, v35, v54
  v_perm_b32 v63, v35, v35, v55
  v_mfma_f32_16x16x32_bf16 v[64:67], v[248:251], v[56:59], v[64:67]
  s_nop 0
  v_mfma_f32_16x16x32_bf16 v[64:67], v[252:255], v[60:63], v[64:67]
  s_waitcnt vmcnt(20)
  v_perm_b32 v56, v36, v36, v48
  v_perm_b32 v57, v36, v36, v49
  v_perm_b32 v58, v36, v36, v50
  v_perm_b32 v59, v36, v36, v51
  v_perm_b32 v60, v36, v36, v52
  v_perm_b32 v61, v36, v36, v53
  v_perm_b32 v62, v36, v36, v54
  v_perm_b32 v63, v36, v36, v55
  v_mfma_f32_16x16x32_bf16 v[64:67], v[76:79], v[56:59], v[64:67]
  v_perm_b32 v56, v37, v37, v48
  v_perm_b32 v57, v37, v37, v49
  v_perm_b32 v58, v37, v37, v50
  v_perm_b32 v59, v37, v37, v51
  v_mfma_f32_16x16x32_bf16 v[64:67], v[80:83], v[60:63], v[64:67]
  v_perm_b32 v60, v37, v37, v52
  v_perm_b32 v61, v37, v37, v53
  v_perm_b32 v62, v37, v37, v54
  v_perm_b32 v63, v37, v37, v55
  v_mfma_f32_16x16x32_bf16 v[64:67], v[84:87], v[56:59], v[64:67]
  s_nop 0
  v_mfma_f32_16x16x32_bf16 v[64:67], v[88:91], v[60:63], v[64:67]
  s_waitcnt vmcnt(16)
  v_perm_b32 v56, v38, v38, v48
  v_perm_b32 v57, v38, v38, v49
  v_perm_b32 v58, v38, v38, v50
  v_perm_b32 v59, v38, v38, v51
  v_perm_b32 v60, v38, v38, v52
  v_perm_b32 v61, v38, v38, v53
  v_perm_b32 v62, v38, v38, v54
  v_perm_b32 v63, v38, v38, v55
  v_mfma_f32_16x16x32_bf16 v[64:67], v[128:131], v[56:59], v[64:67]
  v_perm_b32 v56, v39, v39, v48
  v_perm_b32 v57, v39, v39, v49
  v_perm_b32 v58, v39, v39, v50
  v_perm_b32 v59, v39, v39, v51
  v_mfma_f32_16x16x32_bf16 v[64:67], v[132:135], v[60:63], v[64:67]
  v_perm_b32 v60, v39, v39, v52
  v_perm_b32 v61, v39, v39, v53
  v_perm_b32 v62, v39, v39, v54
  v_perm_b32 v63, v39, v39, v55
  v_mfma_f32_16x16x32_bf16 v[64:67], v[136:139], v[56:59], v[64:67]
  s_nop 0
  v_mfma_f32_16x16x32_bf16 v[64:67], v[140:143], v[60:63], v[64:67]
  s_waitcnt lgkmcnt(0)
  s_waitcnt vmcnt(12)
  v_perm_b32 v56, v40, v40, v48
  v_perm_b32 v57, v40, v40, v49
  v_perm_b32 v58, v40, v40, v50
  v_perm_b32 v59, v40, v40, v51
  v_perm_b32 v60, v40, v40, v52
  v_perm_b32 v61, v40, v40, v53
  v_perm_b32 v62, v40, v40, v54
  v_perm_b32 v63, v40, v40, v55
  v_mfma_f32_16x16x32_bf16 v[64:67], v[144:147], v[56:59], v[64:67]
  v_perm_b32 v56, v41, v41, v48
  v_perm_b32 v57, v41, v41, v49
  v_perm_b32 v58, v41, v41, v50
  v_perm_b32 v59, v41, v41, v51
  v_mfma_f32_16x16x32_bf16 v[64:67], v[148:151], v[60:63], v[64:67]
  v_perm_b32 v60, v41, v41, v52
  v_perm_b32 v61, v41, v41, v53
  v_perm_b32 v62, v41, v41, v54
  v_perm_b32 v63, v41, v41, v55
  v_mfma_f32_16x16x32_bf16 v[64:67], v[152:155], v[56:59], v[64:67]
  s_nop 0
  v_mfma_f32_16x16x32_bf16 v[64:67], v[156:159], v[60:63], v[64:67]
  s_waitcnt vmcnt(8)
  v_perm_b32 v56, v42, v42, v48
  v_perm_b32 v57, v42, v42, v49
  v_perm_b32 v58, v42, v42, v50
  v_perm_b32 v59, v42, v42, v51
  v_perm_b32 v60, v42, v42, v52
  v_perm_b32 v61, v42, v42, v53
  v_perm_b32 v62, v42, v42, v54
  v_perm_b32 v63, v42, v42, v55
  v_mfma_f32_16x16x32_bf16 v[64:67], v[160:163], v[56:59], v[64:67]
  v_perm_b32 v56, v43, v43, v48
  v_perm_b32 v57, v43, v43, v49
  v_perm_b32 v58, v43, v43, v50
  v_perm_b32 v59, v43, v43, v51
  v_mfma_f32_16x16x32_bf16 v[64:67], v[164:167], v[60:63], v[64:67]
  v_perm_b32 v60, v43, v43, v52
  v_perm_b32 v61, v43, v43, v53
  v_perm_b32 v62, v43, v43, v54
  v_perm_b32 v63, v43, v43, v55
  v_mfma_f32_16x16x32_bf16 v[64:67], v[168:171], v[56:59], v[64:67]
  s_nop 0
  v_mfma_f32_16x16x32_bf16 v[64:67], v[172:175], v[60:63], v[64:67]
  s_waitcnt vmcnt(4)
  v_perm_b32 v56, v44, v44, v48
  v_perm_b32 v57, v44, v44, v49
  v_perm_b32 v58, v44, v44, v50
  v_perm_b32 v59, v44, v44, v51
  v_perm_b32 v60, v44, v44, v52
  v_perm_b32 v61, v44, v44, v53
  v_perm_b32 v62, v44, v44, v54
  v_perm_b32 v63, v44, v44, v55
  v_mfma_f32_16x16x32_bf16 v[64:67], v[176:179], v[56:59], v[64:67]
  v_perm_b32 v56, v45, v45, v48
  v_perm_b32 v57, v45, v45, v49
  v_perm_b32 v58, v45, v45, v50
  v_perm_b32 v59, v45, v45, v51
  v_mfma_f32_16x16x32_bf16 v[64:67], v[180:183], v[60:63], v[64:67]
  v_perm_b32 v60, v45, v45, v52
  v_perm_b32 v61, v45, v45, v53
  v_perm_b32 v62, v45, v45, v54
  v_perm_b32 v63, v45, v45, v55
  v_mfma_f32_16x16x32_bf16 v[64:67], v[184:187], v[56:59], v[64:67]
  s_nop 0
  v_mfma_f32_16x16x32_bf16 v[64:67], v[188:191], v[60:63], v[64:67]
  s_waitcnt vmcnt(0)
  v_perm_b32 v56, v46, v46, v48
  v_perm_b32 v57, v46, v46, v49
  v_perm_b32 v58, v46, v46, v50
  v_perm_b32 v59, v46, v46, v51
  v_perm_b32 v60, v46, v46, v52
  v_perm_b32 v61, v46, v46, v53
  v_perm_b32 v62, v46, v46, v54
  v_perm_b32 v63, v46, v46, v55
  v_mfma_f32_16x16x32_bf16 v[64:67], v[192:195], v[56:59], v[64:67]
  v_perm_b32 v56, v47, v47, v48
  v_perm_b32 v57, v47, v47, v49
  v_perm_b32 v58, v47, v47, v50
  v_perm_b32 v59, v47, v47, v51
  v_mfma_f32_16x16x32_bf16 v[64:67], v[196:199], v[60:63], v[64:67]
  v_perm_b32 v60, v47, v47, v52
  v_perm_b32 v61, v47, v47, v53
  v_perm_b32 v62, v47, v47, v54
  v_perm_b32 v63, v47, v47, v55
  v_mfma_f32_16x16x32_bf16 v[64:67], v[200:203], v[56:59], v[64:67]
  s_nop 0
  v_mfma_f32_16x16x32_bf16 v[64:67], v[204:207], v[60:63], v[64:67]
  s_nop 7
  ds_write_b32 v74, v64 offset:0
  ds_write_b32 v74, v65 offset:32
  ds_write_b32 v74, v66 offset:64
  ds_write_b32 v74, v67 offset:96
  s_waitcnt lgkmcnt(0)
  s_barrier
  s_endpgm
L_end:
  s_endpgm
.section .rodata,"a"
.p2align 6
.amdhsa_kernel gated_mix__mha_block_cached__glu_gated_glu__decode_kernel
  .amdhsa_next_free_vgpr 256
  .amdhsa_next_free_sgpr 102
  .amdhsa_accum_offset 256
  .amdhsa_group_segment_fixed_size 0
  .amdhsa_kernarg_size 104
  .amdhsa_user_sgpr_count 2
  .amdhsa_user_sgpr_kernarg_segment_ptr 1
  .amdhsa_system_sgpr_workgroup_id_x 1
.end_amdhsa_kernel
```
